```python
import torch

def _softmax(x, axis=-1):
    return torch.softmax(x, dim=axis)

def _gelu(x):
    return torch.nn.functional.gelu(x, approximate='tanh')

def _silu(x):
    return torch.nn.functional.silu(x)

def _sigmoid(x):
    return torch.sigmoid(x)

def _layernorm(x, axis=-1, eps=1e-05):
    m = x.mean(dim=axis, keepdim=True)
    v = x.var(dim=axis, keepdim=True, unbiased=False)
    return (x - m) / torch.sqrt(v + eps)

def _scatter_add(tgt, idx, src, axis=0):
    return tgt.clone().index_add_(axis, idx, src)

def _segment_sum(src, seg, n):
    out = torch.zeros((n,) + src.shape[1:], dtype=src.dtype)
    return out.index_add_(0, seg, src)

def _pad(x, pw):
    flat = tuple((v for pair in reversed(pw) for v in pair))
    return torch.nn.functional.pad(x, flat)
kernel_name = 'standalone__tree_speculative_verify_tree_attention_over_candidate_token_tree__decode'

def setup_inputs():

    _w = lambda a: (lambda t: t.to(torch.bfloat16) if t.is_floating_point() else t)(torch.as_tensor(a))
    B, Hq, Hkv, T, C, D = (8, 16, 8, 1, 4096, 256)
    tree_mask = torch.zeros((B, T, T), dtype=float)
    for b in range(B):
        parent = torch.zeros(T, dtype=torch.int64)
        for i in range(1, T):
            parent[i] = int(torch.randint(0, i, (1,)).item())
        for i in range(T):
            j = i
            tree_mask[b, i, j] = 1.0
            while j > 0:
                j = parent[j]
                tree_mask[b, i, j] = 1.0
    return {'q': _w((lambda *s: torch.randn(*s, dtype=torch.bfloat16) * 0.8)(B, Hq, T, D)), 'k_cache': _w((lambda *s: torch.randn(*s, dtype=torch.bfloat16) * 0.8)(B, Hkv, C, D)), 'v_cache': _w((lambda *s: torch.randn(*s, dtype=torch.bfloat16) * 0.05)(B, Hkv, C, D)), 'k_tree': _w((lambda *s: torch.randn(*s, dtype=torch.bfloat16) * 0.8)(B, Hkv, T, D)), 'v_tree': _w((lambda *s: torch.randn(*s, dtype=torch.bfloat16) * 0.05)(B, Hkv, T, D)), 'tree_mask': _w(tree_mask)}

def reference(q, k_cache, v_cache, k_tree, v_tree, tree_mask):
    B, Hq, T, D = q.shape
    Hkv, C = (k_cache.shape[1], k_cache.shape[2])
    rep = Hq // Hkv
    kc = (lambda x, n, axis: torch.repeat_interleave(x, n, dim=axis))(k_cache, rep, axis=1)
    vc = (lambda x, n, axis: torch.repeat_interleave(x, n, dim=axis))(v_cache, rep, axis=1)
    kt = (lambda x, n, axis: torch.repeat_interleave(x, n, dim=axis))(k_tree, rep, axis=1)
    vt = (lambda x, n, axis: torch.repeat_interleave(x, n, dim=axis))(v_tree, rep, axis=1)
    k = torch.concatenate([kc, kt], axis=2)
    v = torch.concatenate([vc, vt], axis=2)
    scale = D ** (-0.5)
    scores = torch.einsum('bhqd,bhkd->bhqk', q, k) * scale
    ctx_mask = torch.ones((B, 1, T, C), dtype=scores.dtype)
    tm = tree_mask[:, None, :, :].clone()
    full_mask = torch.concatenate([ctx_mask, tm], axis=-1)
    scores = scores + (1.0 - full_mask) * -1000000000.0
    p = _softmax(scores, axis=-1)
    return torch.einsum('bhqk,bhkd->bhqd', p, v)
```

```asm
; @launch grid=(256,1,1) block=(64,1,1) lds=41728
.amdgcn_target "amdgcn-amd-amdhsa--gfx950"
.text
.globl standalone__tree_speculative_verify_tree_attention_over_candidate_token_tree__decode_kernel
.p2align 8
.type standalone__tree_speculative_verify_tree_attention_over_candidate_token_tree__decode_kernel,@function
standalone__tree_speculative_verify_tree_attention_over_candidate_token_tree__decode_kernel:
  s_cmp_ge_u32 s2, 256
  s_cbranch_scc1 L_end
  s_load_dwordx4 s[4:7], s[0:1], 0
  s_getpc_b64 s[40:41]
L_pc:
  s_sub_u32 s40, s40, L_pc-standalone__tree_speculative_verify_tree_attention_over_candidate_token_tree__decode_kernel
  s_subb_u32 s41, s41, 0
  s_lshr_b32 s42, s2, 3
  s_lshl_b32 s42, s42, 10
  s_cmp_ge_u32 s42, L_codeend-standalone__tree_speculative_verify_tree_attention_over_candidate_token_tree__decode_kernel
  s_cbranch_scc1 L_nocp
  v_lshl_add_u32 v7, v0, 4, s42
  v_min_u32 v7, L_codeend-standalone__tree_speculative_verify_tree_attention_over_candidate_token_tree__decode_kernel-4, v7
  v_mov_b32 v69, s41
  v_add_co_u32 v68, vcc, s40, v7
  s_nop 1
  v_addc_co_u32 v69, vcc, 0, v69, vcc
  global_load_dword v70, v[68:69], off
L_nocp:
  s_bfe_u32 s23, s2, 0x20003
  s_lshr_b32 s40, s2, 5
  s_and_b32 s41, s2, 7
  s_lshl3_add_u32 s42, s40, s40
  s_bfe_u32 s42, s42, 0x30001
  s_xor_b32 s41, s41, s42
  s_lshl3_add_u32 s22, s41, s40
  v_lshrrev_b32 v7, 4, v0
  v_and_b32 v6, 3, v0
  v_lshlrev_b32 v6, 4, v6
  v_lshl_add_u32 v8, v7, 6, v6
  v_bfe_u32 v6, v0, 2, 2
  v_lshl_add_u32 v11, v6, 9, v8
  s_lshr_b32 s40, s2, 6
  s_lshl2_add_u32 s40, s23, s40
  s_and_b32 s41, s40, 1
  s_and_b32 s42, s40, 2
  s_lshl1_add_u32 s41, s42, s41
  s_bfe_u32 s42, s40, 0x10002
  s_lshl1_add_u32 s41, s42, s41
  s_lshl_b32 s41, s41, 11
  v_add_u32 v60, s41, v11
  v_xor_b32 v61, 2048, v60
  v_xor_b32 v62, 8192, v60
  v_xor_b32 v63, 10240, v60
  v_xor_b32 v64, 4096, v60
  v_xor_b32 v65, 6144, v60
  v_xor_b32 v66, 12288, v60
  v_xor_b32 v67, 14336, v60
  v_bfe_u32 v6, v0, 3, 1
  v_lshl_add_u32 v9, v6, 9, v8
  s_and_b32 s41, s40, 8
  s_lshl_b32 s41, s41, 11
  s_lshl_b32 s50, s23, 15
  s_or_b32 s50, s50, s41
  s_mov_b32 s48, s50
  s_xor_b32 s49, s50, 16384
  s_lshl_b32 s41, s22, 21
  s_lshl_b32 s40, s22, 10
  s_mov_b32 s26, 0x200000
  s_mov_b32 s27, 0x20000
  s_mov_b32 s30, 0x200000
  s_mov_b32 s31, 0x20000
  v_mov_b32 v32, 0
  s_waitcnt lgkmcnt(0)
  s_add_u32 s24, s6, s41
  s_addc_u32 s25, s7, 0
  buffer_load_dwordx4 v[84:87], v60, s[24:27], s48 offen nt
  buffer_load_dwordx4 v[88:91], v60, s[24:27], s48 offen offset:256 nt
  s_load_dwordx2 s[20:21], s[0:1], 64
  s_load_dwordx8 s[8:15], s[0:1], 16
  s_load_dwordx4 s[16:19], s[0:1], 48
  s_add_u32 s4, s4, s40
  s_addc_u32 s5, s5, 0
  global_load_dwordx4 v[16:19], v9, s[4:5]
  global_load_dwordx4 v[20:23], v9, s[4:5] offset:256
  s_cmp_lg_u32 s2, 0
  s_cbranch_scc1 L_nonon
  s_waitcnt lgkmcnt(0)
  global_load_dword v43, v32, s[20:21] sc1
  v_lshlrev_b32 v6, 8, v0
  s_mov_b64 exec, 0x14924920
  global_store_dword v6, v32, s[20:21] offset:256 sc1
  s_mov_b64 exec, -1
L_nonon:
  buffer_load_dwordx4 v[92:95], v61, s[24:27], s48 offen nt
  buffer_load_dwordx4 v[96:99], v61, s[24:27], s48 offen offset:256 nt
  buffer_load_dwordx4 v[100:103], v62, s[24:27], s48 offen nt
  buffer_load_dwordx4 v[104:107], v62, s[24:27], s48 offen offset:256 nt
  buffer_load_dwordx4 v[108:111], v63, s[24:27], s48 offen nt
  buffer_load_dwordx4 v[112:115], v63, s[24:27], s48 offen offset:256 nt
  buffer_load_dwordx4 v[116:119], v64, s[24:27], s48 offen nt
  buffer_load_dwordx4 v[120:123], v64, s[24:27], s48 offen offset:256 nt
  buffer_load_dwordx4 v[124:127], v65, s[24:27], s48 offen nt
  buffer_load_dwordx4 v[128:131], v65, s[24:27], s48 offen offset:256 nt
  buffer_load_dwordx4 v[132:135], v66, s[24:27], s48 offen nt
  buffer_load_dwordx4 v[136:139], v66, s[24:27], s48 offen offset:256 nt
  buffer_load_dwordx4 v[140:143], v67, s[24:27], s48 offen nt
  buffer_load_dwordx4 v[144:147], v67, s[24:27], s48 offen offset:256 nt
  s_mov_b64 s[28:29], s[24:25]
  buffer_load_dwordx4 v[148:151], v60, s[28:31], s49 offen nt
  buffer_load_dwordx4 v[152:155], v60, s[28:31], s49 offen offset:256 nt
  buffer_load_dwordx4 v[156:159], v61, s[28:31], s49 offen nt
  buffer_load_dwordx4 v[160:163], v61, s[28:31], s49 offen offset:256 nt
  buffer_load_dwordx4 v[164:167], v62, s[28:31], s49 offen nt
  buffer_load_dwordx4 v[168:171], v62, s[28:31], s49 offen offset:256 nt
  s_waitcnt lgkmcnt(0)
  s_add_u32 s8, s8, s41
  s_addc_u32 s9, s9, 0
  v_and_b32 v6, 15, v0
  v_lshlrev_b32 v6, 4, v6
  v_lshl_add_u32 v7, v7, 9, v6
  v_sub_u32 v11, v7, v11
  s_add_u32 s36, s20, 8448
  s_addc_u32 s37, s21, 0
  s_mov_b32 s38, 2048
  s_mov_b32 s39, 0x20000
  s_mul_i32 s41, s22, 9472
  s_add_u32 s41, s41, 10496
  s_add_u32 s32, s20, s41
  s_addc_u32 s33, s21, 0
  s_mov_b32 s34, 9472
  s_mov_b32 s35, 0x20000
  s_mov_b64 s[44:45], s[18:19]
  s_mov_b32 s46, 256
  s_mov_b32 s47, 0x20000
  s_add_u32 s16, s16, s40
  s_addc_u32 s17, s17, 0
  v_lshlrev_b32 v1, 4, v0
  s_mul_i32 s54, s23, 3072
  v_bfe_u32 v7, v0, 4, 1
  v_lshl_add_u32 v6, v7, 3, v6
  v_lshrrev_b32 v7, 5, v0
  v_lshl_add_u32 v4, v7, 9, v6
  s_cmp_lg_u32 s23, 3
  s_cbranch_scc1 L_notree
  s_lshl_b32 s40, s22, 9
  s_add_u32 s10, s10, s40
  s_addc_u32 s11, s11, 0
  s_add_u32 s12, s12, s40
  s_addc_u32 s13, s13, 0
  s_lshr_b32 s40, s22, 3
  s_lshl_b32 s40, s40, 1
  v_mov_b32 v7, s40
  global_load_dwordx4 v[212:215], v8, s[10:11]
  global_load_dwordx4 v[216:219], v8, s[10:11] offset:256
  global_load_dwordx2 v[220:221], v6, s[12:13]
  global_load_dwordx2 v[222:223], v6, s[12:13] offset:256
  global_load_ushort v224, v7, s[14:15]
L_notree:
  v_mov_b32 v24, 0
  v_mov_b32 v25, 0
  v_mov_b32 v26, 0
  v_mov_b32 v27, 0
  v_mov_b32 v28, 0
  v_mov_b32 v29, 0
  v_mov_b32 v30, 0
  v_mov_b32 v31, 0
  v_mov_b32 v52, 0xfd000000
  v_mov_b32 v53, 0xfd000000
  v_mov_b32 v54, 0xfd000000
  v_mov_b32 v55, 0xfd000000
  v_mov_b32 v56, 0xfd000000
  v_mov_b32 v57, 0xfd000000
  v_mov_b32 v58, 0xfd000000
  v_mov_b32 v59, 0xfd000000
  ds_write_b128 v1, v[24:27] offset:16640
  ds_write_b128 v1, v[24:27] offset:17680
  ds_write_b128 v1, v[24:27] offset:18720
  ds_write_b128 v1, v[24:27] offset:19760
  v_and_b32 v6, 7, v0
  v_mul_u32_u24 v6, 1040, v6
  v_lshrrev_b32 v7, 3, v0
  v_lshl_add_u32 v38, v7, 7, v6
  v_add_u32 v39, 8320, v38
  ds_write2_b32 v39, v52, v52 offset0:0 offset1:5
  ds_write2_b32 v39, v52, v52 offset0:10 offset1:15
  v_lshlrev_b32 v34, 2, v0
  v_mov_b32 v5, 0x3db8aa3b
  v_mov_b32 v10, 0xff7fffff
  v_mov_b32 v3, 0
  v_mov_b32 v36, 0
  v_mov_b32 v37, 0
  v_mov_b32 v33, 0
  s_and_b32 s52, s2, 7
  s_lshl_b32 s52, s52, 8
  v_and_b32 v40, 0x7c, v34
  v_lshrrev_b32 v42, 5, v0
  v_lshlrev_b32 v42, 4, v42
  s_lshr_b32 s40, s2, 3
  s_lshl_b32 s40, s40, 2
  v_lshlrev_b32 v41, 21, v0
  v_add_u32 v41, s40, v41
  s_getreg_b32 s57, hwreg(HW_REG_XCC_ID, 0, 4)
  s_lshl_b32 s57, s57, 1
  s_mov_b32 s51, 0
  s_mov_b32 s55, 0
  s_mov_b32 s53, 0
  s_mov_b32 s11, 0
  s_mov_b32 s10, 3
  s_mov_b32 s58, -1
  s_mov_b32 s59, 0x100
  s_cmp_eq_u32 s23, 3
  s_cselect_b32 s40, 0x80000000, 0
  s_cmp_eq_u32 s2, 0
  s_cselect_b32 s56, 2, 0
  s_or_b32 s56, s56, s40
  s_or_b32 s56, s56, 0x10008
  s_waitcnt vmcnt(20) lgkmcnt(4)
  buffer_load_dwordx4 v[172:175], v63, s[28:31], s49 offen nt
  buffer_load_dwordx4 v[176:179], v63, s[28:31], s49 offen offset:256 nt
  ds_write_b128 v1, v[24:27] offset:20800
  ds_write_b128 v1, v[24:27] offset:21840
  ds_write_b128 v1, v[24:27] offset:22880
  ds_write_b128 v1, v[24:27] offset:23920
  s_waitcnt vmcnt(20) lgkmcnt(4)
  buffer_load_dwordx4 v[180:183], v64, s[28:31], s49 offen nt
  buffer_load_dwordx4 v[184:187], v64, s[28:31], s49 offen offset:256 nt
  ds_write_b128 v1, v[24:27] offset:24960
  ds_write_b128 v1, v[24:27] offset:26000
  ds_write_b128 v1, v[24:27] offset:27040
  ds_write_b128 v1, v[24:27] offset:28080
  s_waitcnt vmcnt(20) lgkmcnt(4)
  buffer_load_dwordx4 v[188:191], v65, s[28:31], s49 offen nt
  buffer_load_dwordx4 v[192:195], v65, s[28:31], s49 offen offset:256 nt
  ds_write_b128 v1, v[24:27] offset:29120
  ds_write_b128 v1, v[24:27] offset:30160
  ds_write_b128 v1, v[24:27] offset:31200
  ds_write_b128 v1, v[24:27] offset:32240
  s_waitcnt vmcnt(20) lgkmcnt(4)
  buffer_load_dwordx4 v[196:199], v66, s[28:31], s49 offen nt
  buffer_load_dwordx4 v[200:203], v66, s[28:31], s49 offen offset:256 nt
L_p1:
  s_add_u32 s51, s51, 1
  s_add_u32 s48, s48, 131072
  s_bitcmp1_b32 s56, s51
  s_cbranch_scc1 L_ev1
L_evb1:
  v_sub_u32 v6, v36, v42
  v_add_u32 v6, 16, v6
  v_cmp_gt_u32 vcc, 0x80, v6
  v_add_u32 v42, 16, v42
  v_readfirstlane_b32 s41, v6
  s_bcnt1_i32_b64 s40, vcc
  s_add_u32 s41, s41, s11
  s_add_u32 s42, s41, 0x80
  s_and_b32 s41, s41, 15
  s_cmp_lt_u32 s42, 0x100
  s_cselect_b32 s14, s41, 6
  s_lshl1_add_u32 s40, s14, s40
  s_cmp_gt_i32 s40, s59
  s_cbranch_scc1 L_k0_2
  s_cmp_le_i32 s40, s58
  s_cbranch_scc1 L_k0_0
  s_waitcnt vmcnt(21)
  buffer_load_dwordx4 v[204:207], v67, s[28:31], s49 offen nt
  buffer_load_dwordx4 v[208:211], v67, s[28:31], s49 offen offset:256 nt
  v_mfma_f32_16x16x32_bf16 v[44:47], v[84:87], v[16:19], 0
  v_mfma_f32_16x16x32_bf16 v[44:47], v[88:91], v[20:23], v[44:47]
  ds_write_b128 v1, v[52:55] offset:14560
  s_waitcnt vmcnt(21)
  buffer_load_dwordx4 v[84:87], v60, s[24:27], s48 offen nt
  buffer_load_dwordx4 v[88:91], v60, s[24:27], s48 offen offset:256 nt
  buffer_store_dword v42, v41, s[36:39], s52 offen
  buffer_load_dword v36, v40, s[36:39], s52 offen sc1
  v_mfma_f32_16x16x32_bf16 v[48:51], v[92:95], v[16:19], 0
  v_mfma_f32_16x16x32_bf16 v[48:51], v[96:99], v[20:23], v[48:51]
  ds_write_b128 v1, v[56:59] offset:15600
  s_waitcnt vmcnt(21)
  buffer_load_dwordx4 v[92:95], v61, s[24:27], s48 offen nt
  buffer_load_dwordx4 v[96:99], v61, s[24:27], s48 offen offset:256 nt
  v_mfma_f32_16x16x32_bf16 v[52:55], v[100:103], v[16:19], 0
  v_mfma_f32_16x16x32_bf16 v[52:55], v[104:107], v[20:23], v[52:55]
  ds_write_b128 v1, v[44:47] offset:0
  ds_read2_b32 v[12:13], v39 offset0:0 offset1:5
  ds_read2_b32 v[14:15], v39 offset0:10 offset1:15
  s_waitcnt vmcnt(21)
  buffer_load_dwordx4 v[100:103], v62, s[24:27], s48 offen nt
  buffer_load_dwordx4 v[104:107], v62, s[24:27], s48 offen offset:256 nt
  v_mfma_f32_16x16x32_bf16 v[56:59], v[108:111], v[16:19], 0
  v_mfma_f32_16x16x32_bf16 v[56:59], v[112:115], v[20:23], v[56:59]
  ds_write_b128 v1, v[48:51] offset:1040
  s_waitcnt vmcnt(21) lgkmcnt(1)
  buffer_load_dwordx4 v[108:111], v63, s[24:27], s48 offen nt
  buffer_load_dwordx4 v[112:115], v63, s[24:27], s48 offen offset:256 nt
  v_mfma_f32_16x16x32_bf16 v[44:47], v[116:119], v[16:19], 0
  v_mfma_f32_16x16x32_bf16 v[44:47], v[120:123], v[20:23], v[44:47]
  ds_write_b128 v1, v[52:55] offset:2080
  v_add_f32 v12, v12, v13
  v_add_f32 v14, v14, v15
  v_add_f32 v12, v12, v14
  v_max_f32 v10, v10, v12
  ds_write_b32 v34, v12 offset:33280
  v_add_u32 v34, 0x100, v34
  s_waitcnt vmcnt(21)
  buffer_load_dwordx4 v[116:119], v64, s[24:27], s48 offen nt
  buffer_load_dwordx4 v[120:123], v64, s[24:27], s48 offen offset:256 nt
  v_mfma_f32_16x16x32_bf16 v[48:51], v[124:127], v[16:19], 0
  v_mfma_f32_16x16x32_bf16 v[48:51], v[128:131], v[20:23], v[48:51]
  ds_write_b128 v1, v[56:59] offset:3120
  s_waitcnt vmcnt(21)
  buffer_load_dwordx4 v[124:127], v65, s[24:27], s48 offen nt
  buffer_load_dwordx4 v[128:131], v65, s[24:27], s48 offen offset:256 nt
  v_mfma_f32_16x16x32_bf16 v[52:55], v[132:135], v[16:19], 0
  v_mfma_f32_16x16x32_bf16 v[52:55], v[136:139], v[20:23], v[52:55]
  ds_write_b128 v1, v[44:47] offset:4160
  s_waitcnt vmcnt(21)
  buffer_load_dwordx4 v[132:135], v66, s[24:27], s48 offen nt
  buffer_load_dwordx4 v[136:139], v66, s[24:27], s48 offen offset:256 nt
  v_mfma_f32_16x16x32_bf16 v[56:59], v[140:143], v[16:19], 0
  v_mfma_f32_16x16x32_bf16 v[56:59], v[144:147], v[20:23], v[56:59]
  ds_write_b128 v1, v[48:51] offset:5200
L_k0_done:
  s_xor_b32 s49, s48, 16384
  s_cmp_eq_u32 s51, 16
  s_cbranch_scc1 L_sw1
L_sw1b:
  v_sub_u32 v6, v37, v42
  v_add_u32 v6, 16, v6
  v_cmp_gt_u32 vcc, 0x80, v6
  v_add_u32 v42, 16, v42
  s_bcnt1_i32_b64 s40, vcc
  s_lshl1_add_u32 s40, s14, s40
  s_cmp_gt_i32 s40, s59
  s_cbranch_scc1 L_k1_2
  s_cmp_le_i32 s40, s58
  s_cbranch_scc1 L_k1_0
  s_waitcnt vmcnt(21)
  buffer_load_dwordx4 v[140:143], v67, s[24:27], s48 offen nt
  buffer_load_dwordx4 v[144:147], v67, s[24:27], s48 offen offset:256 nt
  v_mfma_f32_16x16x32_bf16 v[44:47], v[148:151], v[16:19], 0
  v_mfma_f32_16x16x32_bf16 v[44:47], v[152:155], v[20:23], v[44:47]
  ds_write_b128 v1, v[52:55] offset:6240
  s_waitcnt vmcnt(21)
  buffer_load_dwordx4 v[148:151], v60, s[28:31], s49 offen nt
  buffer_load_dwordx4 v[152:155], v60, s[28:31], s49 offen offset:256 nt
  buffer_store_dword v42, v41, s[36:39], s52 offen
  buffer_load_dword v37, v40, s[36:39], s52 offen sc1
  v_mfma_f32_16x16x32_bf16 v[48:51], v[156:159], v[16:19], 0
  v_mfma_f32_16x16x32_bf16 v[48:51], v[160:163], v[20:23], v[48:51]
  ds_write_b128 v1, v[56:59] offset:7280
  s_waitcnt vmcnt(21)
  buffer_load_dwordx4 v[156:159], v61, s[28:31], s49 offen nt
  buffer_load_dwordx4 v[160:163], v61, s[28:31], s49 offen offset:256 nt
  v_mfma_f32_16x16x32_bf16 v[52:55], v[164:167], v[16:19], 0
  v_mfma_f32_16x16x32_bf16 v[52:55], v[168:171], v[20:23], v[52:55]
  ds_write_b128 v1, v[44:47] offset:8320
  ds_read2_b32 v[12:13], v38 offset0:0 offset1:5
  ds_read2_b32 v[14:15], v38 offset0:10 offset1:15
  s_waitcnt vmcnt(21)
  buffer_load_dwordx4 v[164:167], v62, s[28:31], s49 offen nt
  buffer_load_dwordx4 v[168:171], v62, s[28:31], s49 offen offset:256 nt
  v_mfma_f32_16x16x32_bf16 v[56:59], v[172:175], v[16:19], 0
  v_mfma_f32_16x16x32_bf16 v[56:59], v[176:179], v[20:23], v[56:59]
  ds_write_b128 v1, v[48:51] offset:9360
  s_waitcnt vmcnt(21) lgkmcnt(1)
  buffer_load_dwordx4 v[172:175], v63, s[28:31], s49 offen nt
  buffer_load_dwordx4 v[176:179], v63, s[28:31], s49 offen offset:256 nt
  v_mfma_f32_16x16x32_bf16 v[44:47], v[180:183], v[16:19], 0
  v_mfma_f32_16x16x32_bf16 v[44:47], v[184:187], v[20:23], v[44:47]
  ds_write_b128 v1, v[52:55] offset:10400
  v_add_f32 v12, v12, v13
  v_add_f32 v14, v14, v15
  v_add_f32 v12, v12, v14
  v_max_f32 v10, v10, v12
  ds_write_b32 v34, v12 offset:33280
  v_add_u32 v34, 0x100, v34
  s_waitcnt vmcnt(21)
  buffer_load_dwordx4 v[180:183], v64, s[28:31], s49 offen nt
  buffer_load_dwordx4 v[184:187], v64, s[28:31], s49 offen offset:256 nt
  v_mfma_f32_16x16x32_bf16 v[48:51], v[188:191], v[16:19], 0
  v_mfma_f32_16x16x32_bf16 v[48:51], v[192:195], v[20:23], v[48:51]
  ds_write_b128 v1, v[56:59] offset:11440
  s_waitcnt vmcnt(21)
  buffer_load_dwordx4 v[188:191], v65, s[28:31], s49 offen nt
  buffer_load_dwordx4 v[192:195], v65, s[28:31], s49 offen offset:256 nt
  v_mfma_f32_16x16x32_bf16 v[52:55], v[196:199], v[16:19], 0
  v_mfma_f32_16x16x32_bf16 v[52:55], v[200:203], v[20:23], v[52:55]
  ds_write_b128 v1, v[44:47] offset:12480
  s_waitcnt vmcnt(21)
  buffer_load_dwordx4 v[196:199], v66, s[28:31], s49 offen nt
  buffer_load_dwordx4 v[200:203], v66, s[28:31], s49 offen offset:256 nt
  v_mfma_f32_16x16x32_bf16 v[56:59], v[204:207], v[16:19], 0
  v_mfma_f32_16x16x32_bf16 v[56:59], v[208:211], v[20:23], v[56:59]
  ds_write_b128 v1, v[48:51] offset:13520
L_k1_done:
  s_cmp_lt_u32 s51, 16
  s_cbranch_scc1 L_p1
  ds_write_b128 v1, v[52:55] offset:14560
  s_mov_b32 s40, 9216
  buffer_load_dword v35, off, s[32:35], s40 sc1
  v_add_u32 v38, 16640, v38
  s_nop 1
  ds_write_b128 v1, v[56:59] offset:15600
  ds_read2_b32 v[12:13], v39 offset0:0 offset1:5
  ds_read2_b32 v[14:15], v39 offset0:10 offset1:15
  v_add_u32 v39, 16640, v39
  s_waitcnt lgkmcnt(0)
  v_add_f32 v12, v12, v13
  v_add_f32 v14, v14, v15
  v_add_f32 v12, v12, v14
  v_max_f32 v10, v10, v12
  ds_write_b32 v34, v12 offset:33280
  v_add_u32 v34, 0x100, v34
  v_subrev_u32 v34, 8192, v34
  ds_read_b32 v12, v34 offset:33280
  v_add_u32 v34, 0x100, v34
  v_max_f32_dpp v10, v10, v10 quad_perm:[1,0,3,2] row_mask:0xf bank_mask:0xf
  s_nop 1
  v_max_f32_dpp v10, v10, v10 quad_perm:[2,3,0,1] row_mask:0xf bank_mask:0xf
  s_nop 1
  v_max_f32_dpp v10, v10, v10 row_half_mirror row_mask:0xf bank_mask:0xf
  v_mov_b32 v7, v10
  s_nop 1
  v_permlane16_swap_b32 v10, v7
  v_max_f32 v10, v10, v7
  v_mov_b32 v7, v10
  s_nop 1
  v_permlane32_swap_b32 v10, v7
  v_max_f32 v2, v10, v7
  s_cmp_eq_u32 s23, 3
  s_cbranch_scc1 L_tree
L_treeb:
  s_waitcnt lgkmcnt(0)
  v_sub_f32 v12, v12, v2
  v_mul_f32 v12, v12, v5
  v_exp_f32 v12, v12
  s_nop 0
  v_cvt_pk_bf16_f32 v13, v12, 0
  v_cvt_pk_bf16_f32 v14, 0, v12
  v_add_f32 v3, v3, v14
  ds_write2_b32 v38, v13, v14 offset0:0 offset1:4
  ds_write2_b32 v38, v13, v14 offset0:9 offset1:13
  ds_write2_b32 v38, v13, v14 offset0:18 offset1:22
  ds_write2_b32 v38, v13, v14 offset0:27 offset1:31
  ds_read_b128 v[68:71], v1 offset:16640
  ds_read_b128 v[72:75], v1 offset:17680
L_p2:
  s_add_u32 s51, s51, 1
  s_add_u32 s48, s48, 131072
  s_bitcmp1_b32 s56, s51
  s_cbranch_scc1 L_ev2
L_evb2:
  v_sub_u32 v6, v36, v42
  v_add_u32 v6, 16, v6
  v_cmp_gt_u32 vcc, 0x80, v6
  v_add_u32 v42, 16, v42
  v_readfirstlane_b32 s41, v6
  s_bcnt1_i32_b64 s40, vcc
  s_add_u32 s41, s41, s11
  s_add_u32 s42, s41, 0x80
  s_and_b32 s41, s41, 15
  s_cmp_lt_u32 s42, 0x100
  s_cselect_b32 s14, s41, 6
  s_lshl1_add_u32 s40, s14, s40
  s_cmp_gt_i32 s40, s59
  s_cbranch_scc1 L_v0_2
  s_cmp_le_i32 s40, s58
  s_cbranch_scc1 L_v0_0
  s_waitcnt vmcnt(21) lgkmcnt(1)
  buffer_load_dwordx4 v[204:207], v67, s[28:31], s49 offen nt
  buffer_load_dwordx4 v[208:211], v67, s[28:31], s49 offen offset:256 nt
  ds_read_b128 v[76:79], v1 offset:18720
  ds_read_b32 v12, v34 offset:33280
  v_add_u32 v34, 0x100, v34
  v_mfma_f32_16x16x32_bf16 v[24:27], v[68:71], v[84:87], v[24:27]
  v_mfma_f32_16x16x32_bf16 v[28:31], v[68:71], v[88:91], v[28:31]
  s_waitcnt vmcnt(21) lgkmcnt(2)
  buffer_load_dwordx4 v[84:87], v60, s[24:27], s48 offen nt
  buffer_load_dwordx4 v[88:91], v60, s[24:27], s48 offen offset:256 nt
  buffer_store_dword v42, v41, s[36:39], s52 offen
  buffer_load_dword v36, v40, s[36:39], s52 offen sc1
  ds_read_b128 v[80:83], v1 offset:19760
  v_mfma_f32_16x16x32_bf16 v[24:27], v[72:75], v[92:95], v[24:27]
  v_mfma_f32_16x16x32_bf16 v[28:31], v[72:75], v[96:99], v[28:31]
  s_waitcnt vmcnt(21) lgkmcnt(1)
  buffer_load_dwordx4 v[92:95], v61, s[24:27], s48 offen nt
  buffer_load_dwordx4 v[96:99], v61, s[24:27], s48 offen offset:256 nt
  ds_read_b128 v[68:71], v1 offset:20800
  v_sub_f32 v12, v12, v2
  v_mul_f32 v12, v12, v5
  v_exp_f32 v12, v12
  v_mfma_f32_16x16x32_bf16 v[24:27], v[76:79], v[100:103], v[24:27]
  v_mfma_f32_16x16x32_bf16 v[28:31], v[76:79], v[104:107], v[28:31]
  s_waitcnt vmcnt(21) lgkmcnt(1)
  buffer_load_dwordx4 v[100:103], v62, s[24:27], s48 offen nt
  buffer_load_dwordx4 v[104:107], v62, s[24:27], s48 offen offset:256 nt
  ds_read_b128 v[72:75], v1 offset:21840
  v_mfma_f32_16x16x32_bf16 v[24:27], v[80:83], v[108:111], v[24:27]
  v_mfma_f32_16x16x32_bf16 v[28:31], v[80:83], v[112:115], v[28:31]
  v_cvt_pk_bf16_f32 v13, v12, 0
  v_cvt_pk_bf16_f32 v14, 0, v12
  v_add_f32 v3, v3, v14
  ds_write2_b32 v39, v13, v14 offset0:0 offset1:4
  ds_write2_b32 v39, v13, v14 offset0:9 offset1:13
  ds_write2_b32 v39, v13, v14 offset0:18 offset1:22
  ds_write2_b32 v39, v13, v14 offset0:27 offset1:31
  s_waitcnt vmcnt(21) lgkmcnt(5)
  buffer_load_dwordx4 v[108:111], v63, s[24:27], s48 offen nt
  buffer_load_dwordx4 v[112:115], v63, s[24:27], s48 offen offset:256 nt
  ds_read_b128 v[76:79], v1 offset:22880
  v_mfma_f32_16x16x32_bf16 v[24:27], v[68:71], v[116:119], v[24:27]
  v_mfma_f32_16x16x32_bf16 v[28:31], v[68:71], v[120:123], v[28:31]
  s_waitcnt vmcnt(21) lgkmcnt(5)
  buffer_load_dwordx4 v[116:119], v64, s[24:27], s48 offen nt
  buffer_load_dwordx4 v[120:123], v64, s[24:27], s48 offen offset:256 nt
  ds_read_b128 v[80:83], v1 offset:23920
  v_mfma_f32_16x16x32_bf16 v[24:27], v[72:75], v[124:127], v[24:27]
  v_mfma_f32_16x16x32_bf16 v[28:31], v[72:75], v[128:131], v[28:31]
  s_waitcnt vmcnt(21) lgkmcnt(1)
  buffer_load_dwordx4 v[124:127], v65, s[24:27], s48 offen nt
  buffer_load_dwordx4 v[128:131], v65, s[24:27], s48 offen offset:256 nt
  ds_read_b128 v[68:71], v1 offset:24960
  v_mfma_f32_16x16x32_bf16 v[24:27], v[76:79], v[132:135], v[24:27]
  v_mfma_f32_16x16x32_bf16 v[28:31], v[76:79], v[136:139], v[28:31]
  s_waitcnt vmcnt(21) lgkmcnt(1)
  buffer_load_dwordx4 v[132:135], v66, s[24:27], s48 offen nt
  buffer_load_dwordx4 v[136:139], v66, s[24:27], s48 offen offset:256 nt
  ds_read_b128 v[72:75], v1 offset:26000
  v_mfma_f32_16x16x32_bf16 v[24:27], v[80:83], v[140:143], v[24:27]
  v_mfma_f32_16x16x32_bf16 v[28:31], v[80:83], v[144:147], v[28:31]
L_v0_done:
  s_xor_b32 s49, s48, 16384
  v_sub_u32 v6, v37, v42
  v_add_u32 v6, 16, v6
  v_cmp_gt_u32 vcc, 0x80, v6
  v_add_u32 v42, 16, v42
  s_bcnt1_i32_b64 s40, vcc
  s_lshl1_add_u32 s40, s14, s40
  s_cmp_gt_i32 s40, s59
  s_cbranch_scc1 L_v1_2
  s_cmp_le_i32 s40, s58
  s_cbranch_scc1 L_v1_0
  s_waitcnt vmcnt(21) lgkmcnt(1)
  buffer_load_dwordx4 v[140:143], v67, s[24:27], s48 offen nt
  buffer_load_dwordx4 v[144:147], v67, s[24:27], s48 offen offset:256 nt
  ds_read_b128 v[76:79], v1 offset:27040
  ds_read_b32 v12, v34 offset:33280
  v_add_u32 v34, 0x100, v34
  v_mfma_f32_16x16x32_bf16 v[24:27], v[68:71], v[148:151], v[24:27]
  v_mfma_f32_16x16x32_bf16 v[28:31], v[68:71], v[152:155], v[28:31]
  s_waitcnt vmcnt(21) lgkmcnt(2)
  buffer_load_dwordx4 v[148:151], v60, s[28:31], s49 offen nt
  buffer_load_dwordx4 v[152:155], v60, s[28:31], s49 offen offset:256 nt
  buffer_store_dword v42, v41, s[36:39], s52 offen
  buffer_load_dword v37, v40, s[36:39], s52 offen sc1
  ds_read_b128 v[80:83], v1 offset:28080
  v_mfma_f32_16x16x32_bf16 v[24:27], v[72:75], v[156:159], v[24:27]
  v_mfma_f32_16x16x32_bf16 v[28:31], v[72:75], v[160:163], v[28:31]
  s_waitcnt vmcnt(21) lgkmcnt(1)
  buffer_load_dwordx4 v[156:159], v61, s[28:31], s49 offen nt
  buffer_load_dwordx4 v[160:163], v61, s[28:31], s49 offen offset:256 nt
  ds_read_b128 v[68:71], v1 offset:29120
  v_sub_f32 v12, v12, v2
  v_mul_f32 v12, v12, v5
  v_exp_f32 v12, v12
  v_mfma_f32_16x16x32_bf16 v[24:27], v[76:79], v[164:167], v[24:27]
  v_mfma_f32_16x16x32_bf16 v[28:31], v[76:79], v[168:171], v[28:31]
  s_waitcnt vmcnt(21) lgkmcnt(1)
  buffer_load_dwordx4 v[164:167], v62, s[28:31], s49 offen nt
  buffer_load_dwordx4 v[168:171], v62, s[28:31], s49 offen offset:256 nt
  ds_read_b128 v[72:75], v1 offset:30160
  v_mfma_f32_16x16x32_bf16 v[24:27], v[80:83], v[172:175], v[24:27]
  v_mfma_f32_16x16x32_bf16 v[28:31], v[80:83], v[176:179], v[28:31]
  v_cvt_pk_bf16_f32 v13, v12, 0
  v_cvt_pk_bf16_f32 v14, 0, v12
  v_add_f32 v3, v3, v14
  ds_write2_b32 v38, v13, v14 offset0:0 offset1:4
  ds_write2_b32 v38, v13, v14 offset0:9 offset1:13
  ds_write2_b32 v38, v13, v14 offset0:18 offset1:22
  ds_write2_b32 v38, v13, v14 offset0:27 offset1:31
  s_waitcnt vmcnt(21) lgkmcnt(5)
  buffer_load_dwordx4 v[172:175], v63, s[28:31], s49 offen nt
  buffer_load_dwordx4 v[176:179], v63, s[28:31], s49 offen offset:256 nt
  ds_read_b128 v[76:79], v1 offset:31200
  v_mfma_f32_16x16x32_bf16 v[24:27], v[68:71], v[180:183], v[24:27]
  v_mfma_f32_16x16x32_bf16 v[28:31], v[68:71], v[184:187], v[28:31]
  s_waitcnt vmcnt(21) lgkmcnt(5)
  buffer_load_dwordx4 v[180:183], v64, s[28:31], s49 offen nt
  buffer_load_dwordx4 v[184:187], v64, s[28:31], s49 offen offset:256 nt
  ds_read_b128 v[80:83], v1 offset:32240
  v_mfma_f32_16x16x32_bf16 v[24:27], v[72:75], v[188:191], v[24:27]
  v_mfma_f32_16x16x32_bf16 v[28:31], v[72:75], v[192:195], v[28:31]
  s_waitcnt vmcnt(21) lgkmcnt(1)
  buffer_load_dwordx4 v[188:191], v65, s[28:31], s49 offen nt
  buffer_load_dwordx4 v[192:195], v65, s[28:31], s49 offen offset:256 nt
  ds_read_b128 v[68:71], v1 offset:16640
  v_mfma_f32_16x16x32_bf16 v[24:27], v[76:79], v[196:199], v[24:27]
  v_mfma_f32_16x16x32_bf16 v[28:31], v[76:79], v[200:203], v[28:31]
  s_waitcnt vmcnt(21) lgkmcnt(1)
  buffer_load_dwordx4 v[196:199], v66, s[28:31], s49 offen nt
  buffer_load_dwordx4 v[200:203], v66, s[28:31], s49 offen offset:256 nt
  ds_read_b128 v[72:75], v1 offset:17680
  v_mfma_f32_16x16x32_bf16 v[24:27], v[80:83], v[204:207], v[24:27]
  v_mfma_f32_16x16x32_bf16 v[28:31], v[80:83], v[208:211], v[28:31]
L_v1_done:
  s_cmp_lt_u32 s51, 31
  s_cbranch_scc1 L_p2
  s_waitcnt vmcnt(28) lgkmcnt(1)
  buffer_load_dwordx4 v[204:207], v67, s[28:31], s49 offen nt
  buffer_load_dwordx4 v[208:211], v67, s[28:31], s49 offen offset:256 nt
  ds_read_b128 v[76:79], v1 offset:18720
  ds_read_b32 v12, v34 offset:33280
  v_add_u32 v34, 0x100, v34
  v_mfma_f32_16x16x32_bf16 v[24:27], v[68:71], v[84:87], v[24:27]
  v_mfma_f32_16x16x32_bf16 v[28:31], v[68:71], v[88:91], v[28:31]
  s_waitcnt vmcnt(28) lgkmcnt(2)
  ds_read_b128 v[80:83], v1 offset:19760
  v_mfma_f32_16x16x32_bf16 v[24:27], v[72:75], v[92:95], v[24:27]
  v_mfma_f32_16x16x32_bf16 v[28:31], v[72:75], v[96:99], v[28:31]
  s_waitcnt vmcnt(26) lgkmcnt(1)
  ds_read_b128 v[68:71], v1 offset:20800
  v_sub_f32 v12, v12, v2
  v_mul_f32 v12, v12, v5
  v_exp_f32 v12, v12
  v_mfma_f32_16x16x32_bf16 v[24:27], v[76:79], v[100:103], v[24:27]
  v_mfma_f32_16x16x32_bf16 v[28:31], v[76:79], v[104:107], v[28:31]
  s_waitcnt vmcnt(24) lgkmcnt(1)
  ds_read_b128 v[72:75], v1 offset:21840
  v_mfma_f32_16x16x32_bf16 v[24:27], v[80:83], v[108:111], v[24:27]
  v_mfma_f32_16x16x32_bf16 v[28:31], v[80:83], v[112:115], v[28:31]
  v_cvt_pk_bf16_f32 v13, v12, 0
  v_cvt_pk_bf16_f32 v14, 0, v12
  v_add_f32 v3, v3, v14
  ds_write2_b32 v39, v13, v14 offset0:0 offset1:4
  ds_write2_b32 v39, v13, v14 offset0:9 offset1:13
  ds_write2_b32 v39, v13, v14 offset0:18 offset1:22
  ds_write2_b32 v39, v13, v14 offset0:27 offset1:31
  s_waitcnt vmcnt(22) lgkmcnt(5)
  ds_read_b128 v[76:79], v1 offset:22880
  v_mfma_f32_16x16x32_bf16 v[24:27], v[68:71], v[116:119], v[24:27]
  v_mfma_f32_16x16x32_bf16 v[28:31], v[68:71], v[120:123], v[28:31]
  s_waitcnt vmcnt(20) lgkmcnt(5)
  ds_read_b128 v[80:83], v1 offset:23920
  v_mfma_f32_16x16x32_bf16 v[24:27], v[72:75], v[124:127], v[24:27]
  v_mfma_f32_16x16x32_bf16 v[28:31], v[72:75], v[128:131], v[28:31]
  s_waitcnt vmcnt(18) lgkmcnt(1)
  ds_read_b128 v[68:71], v1 offset:24960
  v_mfma_f32_16x16x32_bf16 v[24:27], v[76:79], v[132:135], v[24:27]
  v_mfma_f32_16x16x32_bf16 v[28:31], v[76:79], v[136:139], v[28:31]
  s_waitcnt vmcnt(16) lgkmcnt(1)
  ds_read_b128 v[72:75], v1 offset:26000
  v_mfma_f32_16x16x32_bf16 v[24:27], v[80:83], v[140:143], v[24:27]
  v_mfma_f32_16x16x32_bf16 v[28:31], v[80:83], v[144:147], v[28:31]
L_tail:
  v_readfirstlane_b32 s53, v33
  v_readfirstlane_b32 s41, v35
  v_mov_b32 v47, v33
  s_cmp_eq_u32 s53, 0
  s_cbranch_scc1 L_noflag
  s_cmp_eq_u32 s23, 3
  s_cbranch_scc1 L_comb
  v_add_f32_dpp v3, v3, v3 quad_perm:[1,0,3,2] row_mask:0xf bank_mask:0xf
  v_mov_b32 v51, v33
  v_mov_b32 v55, v33
  v_add_f32_dpp v3, v3, v3 quad_perm:[2,3,0,1] row_mask:0xf bank_mask:0xf
  s_waitcnt vmcnt(14) lgkmcnt(1)
  ds_read_b128 v[76:79], v1 offset:27040
  v_mfma_f32_16x16x32_bf16 v[24:27], v[68:71], v[148:151], v[24:27]
  v_mfma_f32_16x16x32_bf16 v[28:31], v[68:71], v[152:155], v[28:31]
  v_add_f32_dpp v3, v3, v3 row_half_mirror row_mask:0xf bank_mask:0xf
  v_mov_b32 v7, v3
  s_waitcnt vmcnt(12) lgkmcnt(1)
  ds_read_b128 v[80:83], v1 offset:28080
  v_mfma_f32_16x16x32_bf16 v[24:27], v[72:75], v[156:159], v[24:27]
  v_mfma_f32_16x16x32_bf16 v[28:31], v[72:75], v[160:163], v[28:31]
  v_permlane16_swap_b32 v3, v7
  v_add_f32 v3, v3, v7
  v_mov_b32 v7, v3
  s_waitcnt vmcnt(10) lgkmcnt(1)
  ds_read_b128 v[68:71], v1 offset:29120
  v_mfma_f32_16x16x32_bf16 v[24:27], v[76:79], v[164:167], v[24:27]
  v_mfma_f32_16x16x32_bf16 v[28:31], v[76:79], v[168:171], v[28:31]
  v_permlane32_swap_b32 v3, v7
  v_add_f32 v3, v3, v7
  v_log_f32 v6, v3
  v_rcp_f32 v7, v3
  v_fma_f32 v2, v2, v5, v6
  s_waitcnt vmcnt(8) lgkmcnt(1)
  ds_read_b128 v[72:75], v1 offset:30160
  v_mfma_f32_16x16x32_bf16 v[24:27], v[80:83], v[172:175], v[24:27]
  v_mfma_f32_16x16x32_bf16 v[28:31], v[80:83], v[176:179], v[28:31]
  v_mov_b32_dpp v8, v7 row_newbcast:0 row_mask:0x3 bank_mask:0xf
  v_mov_b32_dpp v54, v2 row_newbcast:0 row_mask:0x3 bank_mask:0xf
  s_xor_b32 s41, s41, s53
  v_mov_b32_dpp v8, v7 row_newbcast:8 row_mask:0xc bank_mask:0xf
  v_mov_b32_dpp v54, v2 row_newbcast:8 row_mask:0xc bank_mask:0xf
  s_waitcnt vmcnt(6) lgkmcnt(1)
  ds_read_b128 v[76:79], v1 offset:31200
  v_mfma_f32_16x16x32_bf16 v[24:27], v[68:71], v[180:183], v[24:27]
  v_mfma_f32_16x16x32_bf16 v[28:31], v[68:71], v[184:187], v[28:31]
  s_waitcnt vmcnt(4) lgkmcnt(1)
  ds_read_b128 v[80:83], v1 offset:32240
  v_mfma_f32_16x16x32_bf16 v[24:27], v[72:75], v[188:191], v[24:27]
  v_mfma_f32_16x16x32_bf16 v[28:31], v[72:75], v[192:195], v[28:31]
  s_waitcnt vmcnt(2) lgkmcnt(1)
  v_mfma_f32_16x16x32_bf16 v[24:27], v[76:79], v[196:199], v[24:27]
  v_mfma_f32_16x16x32_bf16 v[28:31], v[76:79], v[200:203], v[28:31]
  s_waitcnt vmcnt(0) lgkmcnt(0)
  v_mfma_f32_16x16x32_bf16 v[24:27], v[80:83], v[204:207], v[24:27]
  v_mfma_f32_16x16x32_bf16 v[28:31], v[80:83], v[208:211], v[28:31]
  s_cmp_lg_u32 s41, s57
  s_nop 5
  v_mul_f32 v44, v24, v8
  v_mul_f32 v45, v25, v8
  v_mul_f32 v46, v26, v8
  v_mul_f32 v48, v27, v8
  v_mul_f32 v49, v28, v8
  v_mul_f32 v50, v29, v8
  v_mul_f32 v52, v30, v8
  v_mul_f32 v53, v31, v8
  s_cbranch_scc1 L_far
  buffer_store_dwordx4 v[44:47], v1, s[32:35], s54 offen offset:0 nt
  buffer_store_dwordx4 v[48:51], v1, s[32:35], s54 offen offset:1024 nt
  buffer_store_dwordx4 v[52:55], v1, s[32:35], s54 offen offset:2048 nt
  s_endpgm
L_far:
  buffer_store_dwordx4 v[44:47], v1, s[32:35], s54 offen offset:0 sc1
  buffer_store_dwordx4 v[48:51], v1, s[32:35], s54 offen offset:1024 sc1
  buffer_store_dwordx4 v[52:55], v1, s[32:35], s54 offen offset:2048 sc1
  s_endpgm
L_comb:
  v_add_f32_dpp v3, v3, v3 quad_perm:[1,0,3,2] row_mask:0xf bank_mask:0xf
  v_mov_b32 v51, v33
  v_mov_b32 v55, v33
  v_add_f32_dpp v3, v3, v3 quad_perm:[2,3,0,1] row_mask:0xf bank_mask:0xf
  s_waitcnt vmcnt(14) lgkmcnt(1)
  ds_read_b128 v[76:79], v1 offset:27040
  v_mfma_f32_16x16x32_bf16 v[24:27], v[68:71], v[148:151], v[24:27]
  v_mfma_f32_16x16x32_bf16 v[28:31], v[68:71], v[152:155], v[28:31]
  v_add_f32_dpp v3, v3, v3 row_half_mirror row_mask:0xf bank_mask:0xf
  v_mov_b32 v7, v3
  s_waitcnt vmcnt(12) lgkmcnt(1)
  ds_read_b128 v[80:83], v1 offset:28080
  v_mfma_f32_16x16x32_bf16 v[24:27], v[72:75], v[156:159], v[24:27]
  v_mfma_f32_16x16x32_bf16 v[28:31], v[72:75], v[160:163], v[28:31]
  v_permlane16_swap_b32 v3, v7
  v_add_f32 v3, v3, v7
  v_mov_b32 v7, v3
  s_waitcnt vmcnt(10) lgkmcnt(1)
  ds_read_b128 v[68:71], v1 offset:29120
  v_mfma_f32_16x16x32_bf16 v[24:27], v[76:79], v[164:167], v[24:27]
  v_mfma_f32_16x16x32_bf16 v[28:31], v[76:79], v[168:171], v[28:31]
  v_permlane32_swap_b32 v3, v7
  v_add_f32 v3, v3, v7
  v_log_f32 v6, v3
  v_rcp_f32 v7, v3
  v_fma_f32 v2, v2, v5, v6
  s_waitcnt vmcnt(8) lgkmcnt(1)
  ds_read_b128 v[72:75], v1 offset:30160
  v_mfma_f32_16x16x32_bf16 v[24:27], v[80:83], v[172:175], v[24:27]
  v_mfma_f32_16x16x32_bf16 v[28:31], v[80:83], v[176:179], v[28:31]
  v_mov_b32_dpp v8, v7 row_newbcast:0 row_mask:0x3 bank_mask:0xf
  v_mov_b32_dpp v54, v2 row_newbcast:0 row_mask:0x3 bank_mask:0xf
  s_xor_b32 s41, s41, s53
  v_mov_b32_dpp v8, v7 row_newbcast:8 row_mask:0xc bank_mask:0xf
  v_mov_b32_dpp v54, v2 row_newbcast:8 row_mask:0xc bank_mask:0xf
  s_waitcnt vmcnt(6) lgkmcnt(1)
  ds_read_b128 v[76:79], v1 offset:31200
  v_mfma_f32_16x16x32_bf16 v[24:27], v[68:71], v[180:183], v[24:27]
  v_mfma_f32_16x16x32_bf16 v[28:31], v[68:71], v[184:187], v[28:31]
  s_mov_b32 s40, 0
  buffer_load_dwordx4 v[212:215], v1, s[32:35], s40 offen offset:0 sc1
  buffer_load_dwordx4 v[216:219], v1, s[32:35], s40 offen offset:1024 sc1
  buffer_load_dwordx4 v[220:223], v1, s[32:35], s40 offen offset:2048 sc1
  s_mov_b32 s40, 3072
  buffer_load_dwordx4 v[224:227], v1, s[32:35], s40 offen offset:0 sc1
  buffer_load_dwordx4 v[228:231], v1, s[32:35], s40 offen offset:1024 sc1
  buffer_load_dwordx4 v[232:235], v1, s[32:35], s40 offen offset:2048 sc1
  s_mov_b32 s40, 6144
  buffer_load_dwordx4 v[236:239], v1, s[32:35], s40 offen offset:0 sc1
  buffer_load_dwordx4 v[240:243], v1, s[32:35], s40 offen offset:1024 sc1
  buffer_load_dwordx4 v[244:247], v1, s[32:35], s40 offen offset:2048 sc1
  s_waitcnt vmcnt(13) lgkmcnt(1)
  ds_read_b128 v[80:83], v1 offset:32240
  v_mfma_f32_16x16x32_bf16 v[24:27], v[72:75], v[188:191], v[24:27]
  v_mfma_f32_16x16x32_bf16 v[28:31], v[72:75], v[192:195], v[28:31]
  s_waitcnt vmcnt(11) lgkmcnt(1)
  v_mfma_f32_16x16x32_bf16 v[24:27], v[76:79], v[196:199], v[24:27]
  v_mfma_f32_16x16x32_bf16 v[28:31], v[76:79], v[200:203], v[28:31]
  s_waitcnt vmcnt(9) lgkmcnt(0)
  v_mfma_f32_16x16x32_bf16 v[24:27], v[80:83], v[204:207], v[24:27]
  v_mfma_f32_16x16x32_bf16 v[28:31], v[80:83], v[208:211], v[28:31]
  s_mov_b32 s40, 0
  buffer_load_dwordx4 v[84:87], v1, s[32:35], s40 offen offset:0 sc1
  buffer_load_dwordx4 v[88:91], v1, s[32:35], s40 offen offset:1024 sc1
  buffer_load_dwordx4 v[92:95], v1, s[32:35], s40 offen offset:2048 sc1
  s_mov_b32 s40, 3072
  buffer_load_dwordx4 v[96:99], v1, s[32:35], s40 offen offset:0 sc1
  buffer_load_dwordx4 v[100:103], v1, s[32:35], s40 offen offset:1024 sc1
  buffer_load_dwordx4 v[104:107], v1, s[32:35], s40 offen offset:2048 sc1
  s_mov_b32 s40, 6144
  buffer_load_dwordx4 v[108:111], v1, s[32:35], s40 offen offset:0 sc1
  buffer_load_dwordx4 v[112:115], v1, s[32:35], s40 offen offset:1024 sc1
  buffer_load_dwordx4 v[116:119], v1, s[32:35], s40 offen offset:2048 sc1
  v_mul_f32 v44, v24, v8
  v_mul_f32 v45, v25, v8
  v_mul_f32 v46, v26, v8
  v_mul_f32 v48, v27, v8
  v_mul_f32 v49, v28, v8
  v_mul_f32 v50, v29, v8
  v_mul_f32 v52, v30, v8
  v_mul_f32 v53, v31, v8
L_cons:
  s_waitcnt vmcnt(9)
  v_max3_u32 v6, v215, v219, v33
  v_min3_u32 v7, v215, v219, v247
  v_max3_u32 v6, v223, v227, v6
  v_min3_u32 v7, v223, v227, v7
  v_max3_u32 v6, v231, v235, v6
  v_min3_u32 v7, v231, v235, v7
  v_max3_u32 v6, v239, v243, v6
  v_min3_u32 v7, v239, v243, v7
  v_max_u32 v6, v247, v6
  v_min_u32 v7, v33, v7
  v_cmp_ne_u32 vcc, v6, v7
  s_cbranch_vccnz L_tryB
  v_max_f32 v6, v54, v222
  v_max3_f32 v6, v234, v246, v6
  v_sub_f32 v54, v54, v6
  v_sub_f32 v222, v222, v6
  v_sub_f32 v234, v234, v6
  v_sub_f32 v246, v246, v6
  v_exp_f32 v54, v54
  v_exp_f32 v222, v222
  v_exp_f32 v234, v234
  v_exp_f32 v246, v246
  v_add_f32 v7, v54, v222
  v_add_f32 v7, v7, v234
  v_add_f32 v7, v7, v246
  v_rcp_f32 v7, v7
  s_nop 0
  v_mul_f32 v54, v54, v7
  v_mul_f32 v222, v222, v7
  v_mul_f32 v234, v234, v7
  v_mul_f32 v246, v246, v7
  v_mul_f32 v24, v44, v54
  v_mul_f32 v25, v45, v54
  v_mul_f32 v26, v46, v54
  v_mul_f32 v27, v48, v54
  v_fmac_f32 v24, v222, v212
  v_fmac_f32 v25, v222, v213
  v_fmac_f32 v26, v222, v214
  v_fmac_f32 v27, v222, v216
  v_fmac_f32 v24, v234, v224
  v_fmac_f32 v25, v234, v225
  v_fmac_f32 v26, v234, v226
  v_fmac_f32 v27, v234, v228
  v_fmac_f32 v24, v246, v236
  v_fmac_f32 v25, v246, v237
  v_fmac_f32 v26, v246, v238
  v_fmac_f32 v27, v246, v240
  v_cvt_pk_bf16_f32 v12, v24, v25
  v_cvt_pk_bf16_f32 v13, v26, v27
  global_store_dwordx2 v4, v[12:13], s[16:17] offset:0
  v_mul_f32 v28, v49, v54
  v_mul_f32 v29, v50, v54
  v_mul_f32 v30, v52, v54
  v_mul_f32 v31, v53, v54
  v_fmac_f32 v28, v222, v217
  v_fmac_f32 v29, v222, v218
  v_fmac_f32 v30, v222, v220
  v_fmac_f32 v31, v222, v221
  v_fmac_f32 v28, v234, v229
  v_fmac_f32 v29, v234, v230
  v_fmac_f32 v30, v234, v232
  v_fmac_f32 v31, v234, v233
  v_fmac_f32 v28, v246, v241
  v_fmac_f32 v29, v246, v242
  v_fmac_f32 v30, v246, v244
  v_fmac_f32 v31, v246, v245
  v_cvt_pk_bf16_f32 v14, v28, v29
  v_cvt_pk_bf16_f32 v15, v30, v31
  global_store_dwordx2 v4, v[14:15], s[16:17] offset:256
  s_endpgm
L_tryB:
  s_add_u32 s55, s55, 1
  s_cmp_ge_u32 s55, 0x400000
  s_cbranch_scc1 L_end
  s_mov_b32 s40, 0
  buffer_load_dwordx4 v[212:215], v1, s[32:35], s40 offen offset:0 sc1
  buffer_load_dwordx4 v[216:219], v1, s[32:35], s40 offen offset:1024 sc1
  buffer_load_dwordx4 v[220:223], v1, s[32:35], s40 offen offset:2048 sc1
  s_mov_b32 s40, 3072
  buffer_load_dwordx4 v[224:227], v1, s[32:35], s40 offen offset:0 sc1
  buffer_load_dwordx4 v[228:231], v1, s[32:35], s40 offen offset:1024 sc1
  buffer_load_dwordx4 v[232:235], v1, s[32:35], s40 offen offset:2048 sc1
  s_mov_b32 s40, 6144
  buffer_load_dwordx4 v[236:239], v1, s[32:35], s40 offen offset:0 sc1
  buffer_load_dwordx4 v[240:243], v1, s[32:35], s40 offen offset:1024 sc1
  buffer_load_dwordx4 v[244:247], v1, s[32:35], s40 offen offset:2048 sc1
  s_waitcnt vmcnt(9)
  v_max3_u32 v6, v87, v91, v33
  v_min3_u32 v7, v87, v91, v119
  v_max3_u32 v6, v95, v99, v6
  v_min3_u32 v7, v95, v99, v7
  v_max3_u32 v6, v103, v107, v6
  v_min3_u32 v7, v103, v107, v7
  v_max3_u32 v6, v111, v115, v6
  v_min3_u32 v7, v111, v115, v7
  v_max_u32 v6, v119, v6
  v_min_u32 v7, v33, v7
  v_cmp_ne_u32 vcc, v6, v7
  s_cbranch_vccnz L_tryA
  v_max_f32 v6, v54, v94
  v_max3_f32 v6, v106, v118, v6
  v_sub_f32 v54, v54, v6
  v_sub_f32 v94, v94, v6
  v_sub_f32 v106, v106, v6
  v_sub_f32 v118, v118, v6
  v_exp_f32 v54, v54
  v_exp_f32 v94, v94
  v_exp_f32 v106, v106
  v_exp_f32 v118, v118
  v_add_f32 v7, v54, v94
  v_add_f32 v7, v7, v106
  v_add_f32 v7, v7, v118
  v_rcp_f32 v7, v7
  s_nop 0
  v_mul_f32 v54, v54, v7
  v_mul_f32 v94, v94, v7
  v_mul_f32 v106, v106, v7
  v_mul_f32 v118, v118, v7
  v_mul_f32 v24, v44, v54
  v_mul_f32 v25, v45, v54
  v_mul_f32 v26, v46, v54
  v_mul_f32 v27, v48, v54
  v_fmac_f32 v24, v94, v84
  v_fmac_f32 v25, v94, v85
  v_fmac_f32 v26, v94, v86
  v_fmac_f32 v27, v94, v88
  v_fmac_f32 v24, v106, v96
  v_fmac_f32 v25, v106, v97
  v_fmac_f32 v26, v106, v98
  v_fmac_f32 v27, v106, v100
  v_fmac_f32 v24, v118, v108
  v_fmac_f32 v25, v118, v109
  v_fmac_f32 v26, v118, v110
  v_fmac_f32 v27, v118, v112
  v_cvt_pk_bf16_f32 v12, v24, v25
  v_cvt_pk_bf16_f32 v13, v26, v27
  global_store_dwordx2 v4, v[12:13], s[16:17] offset:0
  v_mul_f32 v28, v49, v54
  v_mul_f32 v29, v50, v54
  v_mul_f32 v30, v52, v54
  v_mul_f32 v31, v53, v54
  v_fmac_f32 v28, v94, v89
  v_fmac_f32 v29, v94, v90
  v_fmac_f32 v30, v94, v92
  v_fmac_f32 v31, v94, v93
  v_fmac_f32 v28, v106, v101
  v_fmac_f32 v29, v106, v102
  v_fmac_f32 v30, v106, v104
  v_fmac_f32 v31, v106, v105
  v_fmac_f32 v28, v118, v113
  v_fmac_f32 v29, v118, v114
  v_fmac_f32 v30, v118, v116
  v_fmac_f32 v31, v118, v117
  v_cvt_pk_bf16_f32 v14, v28, v29
  v_cvt_pk_bf16_f32 v15, v30, v31
  global_store_dwordx2 v4, v[14:15], s[16:17] offset:256
L_end:
  s_endpgm
L_tryA:
  s_mov_b32 s40, 0
  buffer_load_dwordx4 v[84:87], v1, s[32:35], s40 offen offset:0 sc1
  buffer_load_dwordx4 v[88:91], v1, s[32:35], s40 offen offset:1024 sc1
  buffer_load_dwordx4 v[92:95], v1, s[32:35], s40 offen offset:2048 sc1
  s_mov_b32 s40, 3072
  buffer_load_dwordx4 v[96:99], v1, s[32:35], s40 offen offset:0 sc1
  buffer_load_dwordx4 v[100:103], v1, s[32:35], s40 offen offset:1024 sc1
  buffer_load_dwordx4 v[104:107], v1, s[32:35], s40 offen offset:2048 sc1
  s_mov_b32 s40, 6144
  buffer_load_dwordx4 v[108:111], v1, s[32:35], s40 offen offset:0 sc1
  buffer_load_dwordx4 v[112:115], v1, s[32:35], s40 offen offset:1024 sc1
  buffer_load_dwordx4 v[116:119], v1, s[32:35], s40 offen offset:2048 sc1
  s_branch L_cons
L_noflag:
  s_add_u32 s55, s55, 1
  s_cmp_ge_u32 s55, 0x400000
  s_cbranch_scc1 L_end
  buffer_load_dword v33, off, s[44:47], 0 offset:128 sc1
  s_waitcnt vmcnt(0)
  s_branch L_tail
L_ev1:
  s_cmp_eq_u32 s51, 16
  s_cbranch_scc1 L_sw0
  s_cmp_lg_u32 s53, 0
  s_cbranch_scc1 L_rk
  s_cmp_lt_u32 s51, 3
  s_cbranch_scc1 L_raise
  s_waitcnt vmcnt(30)
  v_readfirstlane_b32 s53, v33
  s_add_u32 s40, s51, 1
  s_cmp_lg_u32 s53, 0
  s_cbranch_scc1 L_adopt
  s_bitset1_b32 s56, s40
  buffer_load_dword v33, off, s[44:47], 0 offset:128 sc1
  global_load_dword v35, v32, s[8:9] nt
  s_branch L_evb1
L_adopt:
  v_add_u32 v42, v42, v33
  s_mov_b32 s58, 18
  s_mov_b32 s59, 36
  s_cmp_lt_u32 s2, 8
  s_cselect_b32 s40, 0x3db6db60, 0
  s_cselect_b32 s11, 6, 0
  s_or_b32 s56, s56, s40
  v_xor_b32 v7, s57, v33
  s_mov_b64 exec, 1
  v_add_u32 v42, s11, v42
  s_cmp_lg_u32 s23, 3
  s_cbranch_scc1 L_adopt2
  s_mov_b32 s40, 9216
  buffer_store_dword v7, off, s[32:35], s40 sc1
L_adopt2:
  s_mov_b64 exec, -1
  s_branch L_evb1
L_sw0:
  s_mov_b32 s48, s50
  s_mov_b64 s[24:25], s[8:9]
  v_add_u32 v60, v60, v11
  v_add_u32 v61, v61, v11
  v_add_u32 v62, v62, v11
  v_add_u32 v63, v63, v11
  v_add_u32 v64, v64, v11
  v_add_u32 v65, v65, v11
  v_add_u32 v66, v66, v11
  s_branch L_evb1
L_sw1:
  s_mov_b64 s[28:29], s[8:9]
  v_add_u32 v67, v67, v11
  s_branch L_sw1b
L_raise:
  s_waitcnt vmcnt(28)
  v_add_u32 v43, 0x9e3779b8, v43
  v_or_b32 v43, 1, v43
  s_mov_b64 exec, 1
  global_store_dword v32, v43, s[20:21] sc1
  global_atomic_add v32, v43, s[18:19] offset:128
  s_mov_b64 exec, -1
  s_branch L_evb1
L_ev2:
  s_cmp_lg_u32 s51, 31
  s_cbranch_scc1 L_rk
  s_mov_b32 s40, 0
  buffer_load_dwordx4 v[212:215], v1, s[32:35], s40 offen offset:0 sc1
  buffer_load_dwordx4 v[216:219], v1, s[32:35], s40 offen offset:1024 sc1
  buffer_load_dwordx4 v[220:223], v1, s[32:35], s40 offen offset:2048 sc1
  s_mov_b32 s40, 3072
  buffer_load_dwordx4 v[224:227], v1, s[32:35], s40 offen offset:0 sc1
  buffer_load_dwordx4 v[228:231], v1, s[32:35], s40 offen offset:1024 sc1
  buffer_load_dwordx4 v[232:235], v1, s[32:35], s40 offen offset:2048 sc1
  s_mov_b32 s40, 6144
  buffer_load_dwordx4 v[236:239], v1, s[32:35], s40 offen offset:0 sc1
  buffer_load_dwordx4 v[240:243], v1, s[32:35], s40 offen offset:1024 sc1
  buffer_load_dwordx4 v[244:247], v1, s[32:35], s40 offen offset:2048 sc1
  s_branch L_evb2
L_rk:
  s_bitcmp1_b32 0x14924920, s51
  s_cbranch_scc0 L_rk1
  s_mov_b32 s10, 1
  s_lshl_b32 s40, s51, 8
  s_add_u32 s12, s20, s40
  s_addc_u32 s13, s21, 0
  s_atomic_add s10, s[12:13], 256 glc
  s_branch L_rkb
L_rk1:
  s_waitcnt lgkmcnt(0)
  s_lshl_b32 s40, s10, 2
  s_lshr_b32 s40, 0xb9876531, s40
  s_and_b32 s40, s40, 15
  s_sub_u32 s41, s40, s11
  s_mov_b32 s11, s40
  s_mov_b64 exec, 1
  v_add_u32 v42, s41, v42
  s_mov_b64 exec, -1
L_rkb:
  s_cmp_le_u32 s51, 16
  s_cbranch_scc1 L_evb1
  s_branch L_evb2
L_tree:
  v_mfma_f32_16x16x32_bf16 v[44:47], v[212:215], v[16:19], 0
  v_mfma_f32_16x16x32_bf16 v[44:47], v[216:219], v[20:23], v[44:47]
  v_lshlrev_b32 v24, 16, v220
  v_and_b32 v25, 0xffff0000, v220
  v_lshlrev_b32 v26, 16, v221
  v_and_b32 v27, 0xffff0000, v221
  v_lshlrev_b32 v28, 16, v222
  v_and_b32 v29, 0xffff0000, v222
  v_lshlrev_b32 v30, 16, v223
  v_and_b32 v31, 0xffff0000, v223
  v_lshlrev_b32 v224, 16, v224
  v_sub_f32 v224, 1.0, v224
  v_mul_f32 v6, 0xd06e6b28, v224
  s_nop 1
  v_add_f32_dpp v6, v44, v6 quad_perm:[0,0,0,0] row_mask:0xf bank_mask:0xf
  s_nop 1
  v_add_f32_dpp v6, v45, v6 quad_perm:[1,1,1,1] row_mask:0xf bank_mask:0xf
  s_nop 1
  v_add_f32_dpp v6, v46, v6 quad_perm:[2,2,2,2] row_mask:0xf bank_mask:0xf
  s_nop 1
  v_add_f32_dpp v6, v47, v6 quad_perm:[3,3,3,3] row_mask:0xf bank_mask:0xf
  v_max_f32 v2, v2, v6
  v_sub_f32 v6, v6, v2
  v_mul_f32 v6, v6, v5
  v_exp_f32 v8, v6
  s_nop 1
  v_mov_b32_dpp v9, v8 row_newbcast:0 row_mask:0x3 bank_mask:0xf
  v_mul_f32 v3, 0x3d000000, v8
  s_nop 0
  v_mov_b32_dpp v9, v8 row_newbcast:8 row_mask:0xc bank_mask:0xf
  v_mul_f32 v24, v24, v9
  v_mul_f32 v25, v25, v9
  v_mul_f32 v26, v26, v9
  v_mul_f32 v27, v27, v9
  v_mul_f32 v28, v28, v9
  v_mul_f32 v29, v29, v9
  v_mul_f32 v30, v30, v9
  v_mul_f32 v31, v31, v9
  s_branch L_treeb
L_k0_2:
  s_cmp_gt_i32 s40, 50
  s_cbranch_scc1 L_k0_3
  s_waitcnt vmcnt(23)
  buffer_load_dwordx4 v[204:207], v67, s[28:31], s49 offen nt
  buffer_load_dwordx4 v[208:211], v67, s[28:31], s49 offen offset:256 nt
  v_mfma_f32_16x16x32_bf16 v[44:47], v[84:87], v[16:19], 0
  v_mfma_f32_16x16x32_bf16 v[44:47], v[88:91], v[20:23], v[44:47]
  ds_write_b128 v1, v[52:55] offset:14560
  s_waitcnt vmcnt(23)
  buffer_load_dwordx4 v[84:87], v60, s[24:27], s48 offen nt
  buffer_load_dwordx4 v[88:91], v60, s[24:27], s48 offen offset:256 nt
  v_mfma_f32_16x16x32_bf16 v[48:51], v[92:95], v[16:19], 0
  v_mfma_f32_16x16x32_bf16 v[48:51], v[96:99], v[20:23], v[48:51]
  ds_write_b128 v1, v[56:59] offset:15600
  s_waitcnt vmcnt(23)
  buffer_load_dwordx4 v[92:95], v61, s[24:27], s48 offen nt
  buffer_load_dwordx4 v[96:99], v61, s[24:27], s48 offen offset:256 nt
  buffer_store_dword v42, v41, s[36:39], s52 offen
  buffer_load_dword v36, v40, s[36:39], s52 offen sc1
  v_mfma_f32_16x16x32_bf16 v[52:55], v[100:103], v[16:19], 0
  v_mfma_f32_16x16x32_bf16 v[52:55], v[104:107], v[20:23], v[52:55]
  ds_write_b128 v1, v[44:47] offset:0
  ds_read2_b32 v[12:13], v39 offset0:0 offset1:5
  ds_read2_b32 v[14:15], v39 offset0:10 offset1:15
  s_waitcnt vmcnt(23)
  buffer_load_dwordx4 v[100:103], v62, s[24:27], s48 offen nt
  buffer_load_dwordx4 v[104:107], v62, s[24:27], s48 offen offset:256 nt
  v_mfma_f32_16x16x32_bf16 v[56:59], v[108:111], v[16:19], 0
  v_mfma_f32_16x16x32_bf16 v[56:59], v[112:115], v[20:23], v[56:59]
  ds_write_b128 v1, v[48:51] offset:1040
  s_waitcnt vmcnt(23) lgkmcnt(1)
  buffer_load_dwordx4 v[108:111], v63, s[24:27], s48 offen nt
  buffer_load_dwordx4 v[112:115], v63, s[24:27], s48 offen offset:256 nt
  v_mfma_f32_16x16x32_bf16 v[44:47], v[116:119], v[16:19], 0
  v_mfma_f32_16x16x32_bf16 v[44:47], v[120:123], v[20:23], v[44:47]
  ds_write_b128 v1, v[52:55] offset:2080
  v_add_f32 v12, v12, v13
  v_add_f32 v14, v14, v15
  v_add_f32 v12, v12, v14
  v_max_f32 v10, v10, v12
  ds_write_b32 v34, v12 offset:33280
  v_add_u32 v34, 0x100, v34
  s_waitcnt vmcnt(23)
  buffer_load_dwordx4 v[116:119], v64, s[24:27], s48 offen nt
  buffer_load_dwordx4 v[120:123], v64, s[24:27], s48 offen offset:256 nt
  v_mfma_f32_16x16x32_bf16 v[48:51], v[124:127], v[16:19], 0
  v_mfma_f32_16x16x32_bf16 v[48:51], v[128:131], v[20:23], v[48:51]
  ds_write_b128 v1, v[56:59] offset:3120
  s_waitcnt vmcnt(23)
  buffer_load_dwordx4 v[124:127], v65, s[24:27], s48 offen nt
  buffer_load_dwordx4 v[128:131], v65, s[24:27], s48 offen offset:256 nt
  v_mfma_f32_16x16x32_bf16 v[52:55], v[132:135], v[16:19], 0
  v_mfma_f32_16x16x32_bf16 v[52:55], v[136:139], v[20:23], v[52:55]
  ds_write_b128 v1, v[44:47] offset:4160
  s_waitcnt vmcnt(23)
  buffer_load_dwordx4 v[132:135], v66, s[24:27], s48 offen nt
  buffer_load_dwordx4 v[136:139], v66, s[24:27], s48 offen offset:256 nt
  v_mfma_f32_16x16x32_bf16 v[56:59], v[140:143], v[16:19], 0
  v_mfma_f32_16x16x32_bf16 v[56:59], v[144:147], v[20:23], v[56:59]
  ds_write_b128 v1, v[48:51] offset:5200
  s_branch L_k0_done
L_k0_3:
  s_waitcnt vmcnt(27)
  buffer_load_dwordx4 v[204:207], v67, s[28:31], s49 offen nt
  buffer_load_dwordx4 v[208:211], v67, s[28:31], s49 offen offset:256 nt
  v_mfma_f32_16x16x32_bf16 v[44:47], v[84:87], v[16:19], 0
  v_mfma_f32_16x16x32_bf16 v[44:47], v[88:91], v[20:23], v[44:47]
  ds_write_b128 v1, v[52:55] offset:14560
  s_waitcnt vmcnt(27)
  buffer_load_dwordx4 v[84:87], v60, s[24:27], s48 offen nt
  buffer_load_dwordx4 v[88:91], v60, s[24:27], s48 offen offset:256 nt
  v_mfma_f32_16x16x32_bf16 v[48:51], v[92:95], v[16:19], 0
  v_mfma_f32_16x16x32_bf16 v[48:51], v[96:99], v[20:23], v[48:51]
  ds_write_b128 v1, v[56:59] offset:15600
  s_waitcnt vmcnt(27)
  buffer_load_dwordx4 v[92:95], v61, s[24:27], s48 offen nt
  buffer_load_dwordx4 v[96:99], v61, s[24:27], s48 offen offset:256 nt
  v_mfma_f32_16x16x32_bf16 v[52:55], v[100:103], v[16:19], 0
  v_mfma_f32_16x16x32_bf16 v[52:55], v[104:107], v[20:23], v[52:55]
  ds_write_b128 v1, v[44:47] offset:0
  ds_read2_b32 v[12:13], v39 offset0:0 offset1:5
  ds_read2_b32 v[14:15], v39 offset0:10 offset1:15
  s_waitcnt vmcnt(27)
  buffer_load_dwordx4 v[100:103], v62, s[24:27], s48 offen nt
  buffer_load_dwordx4 v[104:107], v62, s[24:27], s48 offen offset:256 nt
  v_mfma_f32_16x16x32_bf16 v[56:59], v[108:111], v[16:19], 0
  v_mfma_f32_16x16x32_bf16 v[56:59], v[112:115], v[20:23], v[56:59]
  ds_write_b128 v1, v[48:51] offset:1040
  s_waitcnt vmcnt(27) lgkmcnt(1)
  buffer_load_dwordx4 v[108:111], v63, s[24:27], s48 offen nt
  buffer_load_dwordx4 v[112:115], v63, s[24:27], s48 offen offset:256 nt
  buffer_store_dword v42, v41, s[36:39], s52 offen
  buffer_load_dword v36, v40, s[36:39], s52 offen sc1
  v_mfma_f32_16x16x32_bf16 v[44:47], v[116:119], v[16:19], 0
  v_mfma_f32_16x16x32_bf16 v[44:47], v[120:123], v[20:23], v[44:47]
  ds_write_b128 v1, v[52:55] offset:2080
  v_add_f32 v12, v12, v13
  v_add_f32 v14, v14, v15
  v_add_f32 v12, v12, v14
  v_max_f32 v10, v10, v12
  ds_write_b32 v34, v12 offset:33280
  v_add_u32 v34, 0x100, v34
  s_waitcnt vmcnt(27)
  buffer_load_dwordx4 v[116:119], v64, s[24:27], s48 offen nt
  buffer_load_dwordx4 v[120:123], v64, s[24:27], s48 offen offset:256 nt
  v_mfma_f32_16x16x32_bf16 v[48:51], v[124:127], v[16:19], 0
  v_mfma_f32_16x16x32_bf16 v[48:51], v[128:131], v[20:23], v[48:51]
  ds_write_b128 v1, v[56:59] offset:3120
  s_waitcnt vmcnt(27)
  buffer_load_dwordx4 v[124:127], v65, s[24:27], s48 offen nt
  buffer_load_dwordx4 v[128:131], v65, s[24:27], s48 offen offset:256 nt
  v_mfma_f32_16x16x32_bf16 v[52:55], v[132:135], v[16:19], 0
  v_mfma_f32_16x16x32_bf16 v[52:55], v[136:139], v[20:23], v[52:55]
  ds_write_b128 v1, v[44:47] offset:4160
  s_waitcnt vmcnt(27)
  buffer_load_dwordx4 v[132:135], v66, s[24:27], s48 offen nt
  buffer_load_dwordx4 v[136:139], v66, s[24:27], s48 offen offset:256 nt
  v_mfma_f32_16x16x32_bf16 v[56:59], v[140:143], v[16:19], 0
  v_mfma_f32_16x16x32_bf16 v[56:59], v[144:147], v[20:23], v[56:59]
  ds_write_b128 v1, v[48:51] offset:5200
  s_branch L_k0_done
L_k0_0:
  s_waitcnt vmcnt(19)
  buffer_load_dwordx4 v[204:207], v67, s[28:31], s49 offen nt
  buffer_load_dwordx4 v[208:211], v67, s[28:31], s49 offen offset:256 nt
  buffer_store_dword v42, v41, s[36:39], s52 offen
  buffer_load_dword v36, v40, s[36:39], s52 offen sc1
  v_mfma_f32_16x16x32_bf16 v[44:47], v[84:87], v[16:19], 0
  v_mfma_f32_16x16x32_bf16 v[44:47], v[88:91], v[20:23], v[44:47]
  ds_write_b128 v1, v[52:55] offset:14560
  s_waitcnt vmcnt(19)
  buffer_load_dwordx4 v[84:87], v60, s[24:27], s48 offen nt
  buffer_load_dwordx4 v[88:91], v60, s[24:27], s48 offen offset:256 nt
  v_mfma_f32_16x16x32_bf16 v[48:51], v[92:95], v[16:19], 0
  v_mfma_f32_16x16x32_bf16 v[48:51], v[96:99], v[20:23], v[48:51]
  ds_write_b128 v1, v[56:59] offset:15600
  s_waitcnt vmcnt(19)
  buffer_load_dwordx4 v[92:95], v61, s[24:27], s48 offen nt
  buffer_load_dwordx4 v[96:99], v61, s[24:27], s48 offen offset:256 nt
  v_mfma_f32_16x16x32_bf16 v[52:55], v[100:103], v[16:19], 0
  v_mfma_f32_16x16x32_bf16 v[52:55], v[104:107], v[20:23], v[52:55]
  ds_write_b128 v1, v[44:47] offset:0
  ds_read2_b32 v[12:13], v39 offset0:0 offset1:5
  ds_read2_b32 v[14:15], v39 offset0:10 offset1:15
  s_waitcnt vmcnt(19)
  buffer_load_dwordx4 v[100:103], v62, s[24:27], s48 offen nt
  buffer_load_dwordx4 v[104:107], v62, s[24:27], s48 offen offset:256 nt
  v_mfma_f32_16x16x32_bf16 v[56:59], v[108:111], v[16:19], 0
  v_mfma_f32_16x16x32_bf16 v[56:59], v[112:115], v[20:23], v[56:59]
  ds_write_b128 v1, v[48:51] offset:1040
  s_waitcnt vmcnt(19) lgkmcnt(1)
  buffer_load_dwordx4 v[108:111], v63, s[24:27], s48 offen nt
  buffer_load_dwordx4 v[112:115], v63, s[24:27], s48 offen offset:256 nt
  v_mfma_f32_16x16x32_bf16 v[44:47], v[116:119], v[16:19], 0
  v_mfma_f32_16x16x32_bf16 v[44:47], v[120:123], v[20:23], v[44:47]
  ds_write_b128 v1, v[52:55] offset:2080
  v_add_f32 v12, v12, v13
  v_add_f32 v14, v14, v15
  v_add_f32 v12, v12, v14
  v_max_f32 v10, v10, v12
  ds_write_b32 v34, v12 offset:33280
  v_add_u32 v34, 0x100, v34
  s_waitcnt vmcnt(19)
  buffer_load_dwordx4 v[116:119], v64, s[24:27], s48 offen nt
  buffer_load_dwordx4 v[120:123], v64, s[24:27], s48 offen offset:256 nt
  v_mfma_f32_16x16x32_bf16 v[48:51], v[124:127], v[16:19], 0
  v_mfma_f32_16x16x32_bf16 v[48:51], v[128:131], v[20:23], v[48:51]
  ds_write_b128 v1, v[56:59] offset:3120
  s_waitcnt vmcnt(19)
  buffer_load_dwordx4 v[124:127], v65, s[24:27], s48 offen nt
  buffer_load_dwordx4 v[128:131], v65, s[24:27], s48 offen offset:256 nt
  v_mfma_f32_16x16x32_bf16 v[52:55], v[132:135], v[16:19], 0
  v_mfma_f32_16x16x32_bf16 v[52:55], v[136:139], v[20:23], v[52:55]
  ds_write_b128 v1, v[44:47] offset:4160
  s_waitcnt vmcnt(19)
  buffer_load_dwordx4 v[132:135], v66, s[24:27], s48 offen nt
  buffer_load_dwordx4 v[136:139], v66, s[24:27], s48 offen offset:256 nt
  v_mfma_f32_16x16x32_bf16 v[56:59], v[140:143], v[16:19], 0
  v_mfma_f32_16x16x32_bf16 v[56:59], v[144:147], v[20:23], v[56:59]
  ds_write_b128 v1, v[48:51] offset:5200
  s_branch L_k0_done
L_k1_2:
  s_cmp_gt_i32 s40, 50
  s_cbranch_scc1 L_k1_3
  s_waitcnt vmcnt(23)
  buffer_load_dwordx4 v[140:143], v67, s[24:27], s48 offen nt
  buffer_load_dwordx4 v[144:147], v67, s[24:27], s48 offen offset:256 nt
  v_mfma_f32_16x16x32_bf16 v[44:47], v[148:151], v[16:19], 0
  v_mfma_f32_16x16x32_bf16 v[44:47], v[152:155], v[20:23], v[44:47]
  ds_write_b128 v1, v[52:55] offset:6240
  s_waitcnt vmcnt(23)
  buffer_load_dwordx4 v[148:151], v60, s[28:31], s49 offen nt
  buffer_load_dwordx4 v[152:155], v60, s[28:31], s49 offen offset:256 nt
  v_mfma_f32_16x16x32_bf16 v[48:51], v[156:159], v[16:19], 0
  v_mfma_f32_16x16x32_bf16 v[48:51], v[160:163], v[20:23], v[48:51]
  ds_write_b128 v1, v[56:59] offset:7280
  s_waitcnt vmcnt(23)
  buffer_load_dwordx4 v[156:159], v61, s[28:31], s49 offen nt
  buffer_load_dwordx4 v[160:163], v61, s[28:31], s49 offen offset:256 nt
  buffer_store_dword v42, v41, s[36:39], s52 offen
  buffer_load_dword v37, v40, s[36:39], s52 offen sc1
  v_mfma_f32_16x16x32_bf16 v[52:55], v[164:167], v[16:19], 0
  v_mfma_f32_16x16x32_bf16 v[52:55], v[168:171], v[20:23], v[52:55]
  ds_write_b128 v1, v[44:47] offset:8320
  ds_read2_b32 v[12:13], v38 offset0:0 offset1:5
  ds_read2_b32 v[14:15], v38 offset0:10 offset1:15
  s_waitcnt vmcnt(23)
  buffer_load_dwordx4 v[164:167], v62, s[28:31], s49 offen nt
  buffer_load_dwordx4 v[168:171], v62, s[28:31], s49 offen offset:256 nt
  v_mfma_f32_16x16x32_bf16 v[56:59], v[172:175], v[16:19], 0
  v_mfma_f32_16x16x32_bf16 v[56:59], v[176:179], v[20:23], v[56:59]
  ds_write_b128 v1, v[48:51] offset:9360
  s_waitcnt vmcnt(23) lgkmcnt(1)
  buffer_load_dwordx4 v[172:175], v63, s[28:31], s49 offen nt
  buffer_load_dwordx4 v[176:179], v63, s[28:31], s49 offen offset:256 nt
  v_mfma_f32_16x16x32_bf16 v[44:47], v[180:183], v[16:19], 0
  v_mfma_f32_16x16x32_bf16 v[44:47], v[184:187], v[20:23], v[44:47]
  ds_write_b128 v1, v[52:55] offset:10400
  v_add_f32 v12, v12, v13
  v_add_f32 v14, v14, v15
  v_add_f32 v12, v12, v14
  v_max_f32 v10, v10, v12
  ds_write_b32 v34, v12 offset:33280
  v_add_u32 v34, 0x100, v34
  s_waitcnt vmcnt(23)
  buffer_load_dwordx4 v[180:183], v64, s[28:31], s49 offen nt
  buffer_load_dwordx4 v[184:187], v64, s[28:31], s49 offen offset:256 nt
  v_mfma_f32_16x16x32_bf16 v[48:51], v[188:191], v[16:19], 0
  v_mfma_f32_16x16x32_bf16 v[48:51], v[192:195], v[20:23], v[48:51]
  ds_write_b128 v1, v[56:59] offset:11440
  s_waitcnt vmcnt(23)
  buffer_load_dwordx4 v[188:191], v65, s[28:31], s49 offen nt
  buffer_load_dwordx4 v[192:195], v65, s[28:31], s49 offen offset:256 nt
  v_mfma_f32_16x16x32_bf16 v[52:55], v[196:199], v[16:19], 0
  v_mfma_f32_16x16x32_bf16 v[52:55], v[200:203], v[20:23], v[52:55]
  ds_write_b128 v1, v[44:47] offset:12480
  s_waitcnt vmcnt(23)
  buffer_load_dwordx4 v[196:199], v66, s[28:31], s49 offen nt
  buffer_load_dwordx4 v[200:203], v66, s[28:31], s49 offen offset:256 nt
  v_mfma_f32_16x16x32_bf16 v[56:59], v[204:207], v[16:19], 0
  v_mfma_f32_16x16x32_bf16 v[56:59], v[208:211], v[20:23], v[56:59]
  ds_write_b128 v1, v[48:51] offset:13520
  s_branch L_k1_done
L_k1_3:
  s_waitcnt vmcnt(27)
  buffer_load_dwordx4 v[140:143], v67, s[24:27], s48 offen nt
  buffer_load_dwordx4 v[144:147], v67, s[24:27], s48 offen offset:256 nt
  v_mfma_f32_16x16x32_bf16 v[44:47], v[148:151], v[16:19], 0
  v_mfma_f32_16x16x32_bf16 v[44:47], v[152:155], v[20:23], v[44:47]
  ds_write_b128 v1, v[52:55] offset:6240
  s_waitcnt vmcnt(27)
  buffer_load_dwordx4 v[148:151], v60, s[28:31], s49 offen nt
  buffer_load_dwordx4 v[152:155], v60, s[28:31], s49 offen offset:256 nt
  v_mfma_f32_16x16x32_bf16 v[48:51], v[156:159], v[16:19], 0
  v_mfma_f32_16x16x32_bf16 v[48:51], v[160:163], v[20:23], v[48:51]
  ds_write_b128 v1, v[56:59] offset:7280
  s_waitcnt vmcnt(27)
  buffer_load_dwordx4 v[156:159], v61, s[28:31], s49 offen nt
  buffer_load_dwordx4 v[160:163], v61, s[28:31], s49 offen offset:256 nt
  v_mfma_f32_16x16x32_bf16 v[52:55], v[164:167], v[16:19], 0
  v_mfma_f32_16x16x32_bf16 v[52:55], v[168:171], v[20:23], v[52:55]
  ds_write_b128 v1, v[44:47] offset:8320
  ds_read2_b32 v[12:13], v38 offset0:0 offset1:5
  ds_read2_b32 v[14:15], v38 offset0:10 offset1:15
  s_waitcnt vmcnt(27)
  buffer_load_dwordx4 v[164:167], v62, s[28:31], s49 offen nt
  buffer_load_dwordx4 v[168:171], v62, s[28:31], s49 offen offset:256 nt
  v_mfma_f32_16x16x32_bf16 v[56:59], v[172:175], v[16:19], 0
  v_mfma_f32_16x16x32_bf16 v[56:59], v[176:179], v[20:23], v[56:59]
  ds_write_b128 v1, v[48:51] offset:9360
  s_waitcnt vmcnt(27) lgkmcnt(1)
  buffer_load_dwordx4 v[172:175], v63, s[28:31], s49 offen nt
  buffer_load_dwordx4 v[176:179], v63, s[28:31], s49 offen offset:256 nt
  buffer_store_dword v42, v41, s[36:39], s52 offen
  buffer_load_dword v37, v40, s[36:39], s52 offen sc1
  v_mfma_f32_16x16x32_bf16 v[44:47], v[180:183], v[16:19], 0
  v_mfma_f32_16x16x32_bf16 v[44:47], v[184:187], v[20:23], v[44:47]
  ds_write_b128 v1, v[52:55] offset:10400
  v_add_f32 v12, v12, v13
  v_add_f32 v14, v14, v15
  v_add_f32 v12, v12, v14
  v_max_f32 v10, v10, v12
  ds_write_b32 v34, v12 offset:33280
  v_add_u32 v34, 0x100, v34
  s_waitcnt vmcnt(27)
  buffer_load_dwordx4 v[180:183], v64, s[28:31], s49 offen nt
  buffer_load_dwordx4 v[184:187], v64, s[28:31], s49 offen offset:256 nt
  v_mfma_f32_16x16x32_bf16 v[48:51], v[188:191], v[16:19], 0
  v_mfma_f32_16x16x32_bf16 v[48:51], v[192:195], v[20:23], v[48:51]
  ds_write_b128 v1, v[56:59] offset:11440
  s_waitcnt vmcnt(27)
  buffer_load_dwordx4 v[188:191], v65, s[28:31], s49 offen nt
  buffer_load_dwordx4 v[192:195], v65, s[28:31], s49 offen offset:256 nt
  v_mfma_f32_16x16x32_bf16 v[52:55], v[196:199], v[16:19], 0
  v_mfma_f32_16x16x32_bf16 v[52:55], v[200:203], v[20:23], v[52:55]
  ds_write_b128 v1, v[44:47] offset:12480
  s_waitcnt vmcnt(27)
  buffer_load_dwordx4 v[196:199], v66, s[28:31], s49 offen nt
  buffer_load_dwordx4 v[200:203], v66, s[28:31], s49 offen offset:256 nt
  v_mfma_f32_16x16x32_bf16 v[56:59], v[204:207], v[16:19], 0
  v_mfma_f32_16x16x32_bf16 v[56:59], v[208:211], v[20:23], v[56:59]
  ds_write_b128 v1, v[48:51] offset:13520
  s_branch L_k1_done
L_k1_0:
  s_waitcnt vmcnt(19)
  buffer_load_dwordx4 v[140:143], v67, s[24:27], s48 offen nt
  buffer_load_dwordx4 v[144:147], v67, s[24:27], s48 offen offset:256 nt
  buffer_store_dword v42, v41, s[36:39], s52 offen
  buffer_load_dword v37, v40, s[36:39], s52 offen sc1
  v_mfma_f32_16x16x32_bf16 v[44:47], v[148:151], v[16:19], 0
  v_mfma_f32_16x16x32_bf16 v[44:47], v[152:155], v[20:23], v[44:47]
  ds_write_b128 v1, v[52:55] offset:6240
  s_waitcnt vmcnt(19)
  buffer_load_dwordx4 v[148:151], v60, s[28:31], s49 offen nt
  buffer_load_dwordx4 v[152:155], v60, s[28:31], s49 offen offset:256 nt
  v_mfma_f32_16x16x32_bf16 v[48:51], v[156:159], v[16:19], 0
  v_mfma_f32_16x16x32_bf16 v[48:51], v[160:163], v[20:23], v[48:51]
  ds_write_b128 v1, v[56:59] offset:7280
  s_waitcnt vmcnt(19)
  buffer_load_dwordx4 v[156:159], v61, s[28:31], s49 offen nt
  buffer_load_dwordx4 v[160:163], v61, s[28:31], s49 offen offset:256 nt
  v_mfma_f32_16x16x32_bf16 v[52:55], v[164:167], v[16:19], 0
  v_mfma_f32_16x16x32_bf16 v[52:55], v[168:171], v[20:23], v[52:55]
  ds_write_b128 v1, v[44:47] offset:8320
  ds_read2_b32 v[12:13], v38 offset0:0 offset1:5
  ds_read2_b32 v[14:15], v38 offset0:10 offset1:15
  s_waitcnt vmcnt(19)
  buffer_load_dwordx4 v[164:167], v62, s[28:31], s49 offen nt
  buffer_load_dwordx4 v[168:171], v62, s[28:31], s49 offen offset:256 nt
  v_mfma_f32_16x16x32_bf16 v[56:59], v[172:175], v[16:19], 0
  v_mfma_f32_16x16x32_bf16 v[56:59], v[176:179], v[20:23], v[56:59]
  ds_write_b128 v1, v[48:51] offset:9360
  s_waitcnt vmcnt(19) lgkmcnt(1)
  buffer_load_dwordx4 v[172:175], v63, s[28:31], s49 offen nt
  buffer_load_dwordx4 v[176:179], v63, s[28:31], s49 offen offset:256 nt
  v_mfma_f32_16x16x32_bf16 v[44:47], v[180:183], v[16:19], 0
  v_mfma_f32_16x16x32_bf16 v[44:47], v[184:187], v[20:23], v[44:47]
  ds_write_b128 v1, v[52:55] offset:10400
  v_add_f32 v12, v12, v13
  v_add_f32 v14, v14, v15
  v_add_f32 v12, v12, v14
  v_max_f32 v10, v10, v12
  ds_write_b32 v34, v12 offset:33280
  v_add_u32 v34, 0x100, v34
  s_waitcnt vmcnt(19)
  buffer_load_dwordx4 v[180:183], v64, s[28:31], s49 offen nt
  buffer_load_dwordx4 v[184:187], v64, s[28:31], s49 offen offset:256 nt
  v_mfma_f32_16x16x32_bf16 v[48:51], v[188:191], v[16:19], 0
  v_mfma_f32_16x16x32_bf16 v[48:51], v[192:195], v[20:23], v[48:51]
  ds_write_b128 v1, v[56:59] offset:11440
  s_waitcnt vmcnt(19)
  buffer_load_dwordx4 v[188:191], v65, s[28:31], s49 offen nt
  buffer_load_dwordx4 v[192:195], v65, s[28:31], s49 offen offset:256 nt
  v_mfma_f32_16x16x32_bf16 v[52:55], v[196:199], v[16:19], 0
  v_mfma_f32_16x16x32_bf16 v[52:55], v[200:203], v[20:23], v[52:55]
  ds_write_b128 v1, v[44:47] offset:12480
  s_waitcnt vmcnt(19)
  buffer_load_dwordx4 v[196:199], v66, s[28:31], s49 offen nt
  buffer_load_dwordx4 v[200:203], v66, s[28:31], s49 offen offset:256 nt
  v_mfma_f32_16x16x32_bf16 v[56:59], v[204:207], v[16:19], 0
  v_mfma_f32_16x16x32_bf16 v[56:59], v[208:211], v[20:23], v[56:59]
  ds_write_b128 v1, v[48:51] offset:13520
  s_branch L_k1_done
L_v0_2:
  s_cmp_gt_i32 s40, 50
  s_cbranch_scc1 L_v0_3
  s_waitcnt vmcnt(23) lgkmcnt(1)
  buffer_load_dwordx4 v[204:207], v67, s[28:31], s49 offen nt
  buffer_load_dwordx4 v[208:211], v67, s[28:31], s49 offen offset:256 nt
  ds_read_b128 v[76:79], v1 offset:18720
  ds_read_b32 v12, v34 offset:33280
  v_add_u32 v34, 0x100, v34
  v_mfma_f32_16x16x32_bf16 v[24:27], v[68:71], v[84:87], v[24:27]
  v_mfma_f32_16x16x32_bf16 v[28:31], v[68:71], v[88:91], v[28:31]
  s_waitcnt vmcnt(23) lgkmcnt(2)
  buffer_load_dwordx4 v[84:87], v60, s[24:27], s48 offen nt
  buffer_load_dwordx4 v[88:91], v60, s[24:27], s48 offen offset:256 nt
  ds_read_b128 v[80:83], v1 offset:19760
  v_mfma_f32_16x16x32_bf16 v[24:27], v[72:75], v[92:95], v[24:27]
  v_mfma_f32_16x16x32_bf16 v[28:31], v[72:75], v[96:99], v[28:31]
  s_waitcnt vmcnt(23) lgkmcnt(1)
  buffer_load_dwordx4 v[92:95], v61, s[24:27], s48 offen nt
  buffer_load_dwordx4 v[96:99], v61, s[24:27], s48 offen offset:256 nt
  buffer_store_dword v42, v41, s[36:39], s52 offen
  buffer_load_dword v36, v40, s[36:39], s52 offen sc1
  ds_read_b128 v[68:71], v1 offset:20800
  v_sub_f32 v12, v12, v2
  v_mul_f32 v12, v12, v5
  v_exp_f32 v12, v12
  v_mfma_f32_16x16x32_bf16 v[24:27], v[76:79], v[100:103], v[24:27]
  v_mfma_f32_16x16x32_bf16 v[28:31], v[76:79], v[104:107], v[28:31]
  s_waitcnt vmcnt(23) lgkmcnt(1)
  buffer_load_dwordx4 v[100:103], v62, s[24:27], s48 offen nt
  buffer_load_dwordx4 v[104:107], v62, s[24:27], s48 offen offset:256 nt
  ds_read_b128 v[72:75], v1 offset:21840
  v_mfma_f32_16x16x32_bf16 v[24:27], v[80:83], v[108:111], v[24:27]
  v_mfma_f32_16x16x32_bf16 v[28:31], v[80:83], v[112:115], v[28:31]
  v_cvt_pk_bf16_f32 v13, v12, 0
  v_cvt_pk_bf16_f32 v14, 0, v12
  v_add_f32 v3, v3, v14
  ds_write2_b32 v39, v13, v14 offset0:0 offset1:4
  ds_write2_b32 v39, v13, v14 offset0:9 offset1:13
  ds_write2_b32 v39, v13, v14 offset0:18 offset1:22
  ds_write2_b32 v39, v13, v14 offset0:27 offset1:31
  s_waitcnt vmcnt(23) lgkmcnt(5)
  buffer_load_dwordx4 v[108:111], v63, s[24:27], s48 offen nt
  buffer_load_dwordx4 v[112:115], v63, s[24:27], s48 offen offset:256 nt
  ds_read_b128 v[76:79], v1 offset:22880
  v_mfma_f32_16x16x32_bf16 v[24:27], v[68:71], v[116:119], v[24:27]
  v_mfma_f32_16x16x32_bf16 v[28:31], v[68:71], v[120:123], v[28:31]
  s_waitcnt vmcnt(23) lgkmcnt(5)
  buffer_load_dwordx4 v[116:119], v64, s[24:27], s48 offen nt
  buffer_load_dwordx4 v[120:123], v64, s[24:27], s48 offen offset:256 nt
  ds_read_b128 v[80:83], v1 offset:23920
  v_mfma_f32_16x16x32_bf16 v[24:27], v[72:75], v[124:127], v[24:27]
  v_mfma_f32_16x16x32_bf16 v[28:31], v[72:75], v[128:131], v[28:31]
  s_waitcnt vmcnt(23) lgkmcnt(1)
  buffer_load_dwordx4 v[124:127], v65, s[24:27], s48 offen nt
  buffer_load_dwordx4 v[128:131], v65, s[24:27], s48 offen offset:256 nt
  ds_read_b128 v[68:71], v1 offset:24960
  v_mfma_f32_16x16x32_bf16 v[24:27], v[76:79], v[132:135], v[24:27]
  v_mfma_f32_16x16x32_bf16 v[28:31], v[76:79], v[136:139], v[28:31]
  s_waitcnt vmcnt(23) lgkmcnt(1)
  buffer_load_dwordx4 v[132:135], v66, s[24:27], s48 offen nt
  buffer_load_dwordx4 v[136:139], v66, s[24:27], s48 offen offset:256 nt
  ds_read_b128 v[72:75], v1 offset:26000
  v_mfma_f32_16x16x32_bf16 v[24:27], v[80:83], v[140:143], v[24:27]
  v_mfma_f32_16x16x32_bf16 v[28:31], v[80:83], v[144:147], v[28:31]
  s_branch L_v0_done
L_v0_3:
  s_waitcnt vmcnt(27) lgkmcnt(1)
  buffer_load_dwordx4 v[204:207], v67, s[28:31], s49 offen nt
  buffer_load_dwordx4 v[208:211], v67, s[28:31], s49 offen offset:256 nt
  ds_read_b128 v[76:79], v1 offset:18720
  ds_read_b32 v12, v34 offset:33280
  v_add_u32 v34, 0x100, v34
  v_mfma_f32_16x16x32_bf16 v[24:27], v[68:71], v[84:87], v[24:27]
  v_mfma_f32_16x16x32_bf16 v[28:31], v[68:71], v[88:91], v[28:31]
  s_waitcnt vmcnt(27) lgkmcnt(2)
  buffer_load_dwordx4 v[84:87], v60, s[24:27], s48 offen nt
  buffer_load_dwordx4 v[88:91], v60, s[24:27], s48 offen offset:256 nt
  ds_read_b128 v[80:83], v1 offset:19760
  v_mfma_f32_16x16x32_bf16 v[24:27], v[72:75], v[92:95], v[24:27]
  v_mfma_f32_16x16x32_bf16 v[28:31], v[72:75], v[96:99], v[28:31]
  s_waitcnt vmcnt(27) lgkmcnt(1)
  buffer_load_dwordx4 v[92:95], v61, s[24:27], s48 offen nt
  buffer_load_dwordx4 v[96:99], v61, s[24:27], s48 offen offset:256 nt
  ds_read_b128 v[68:71], v1 offset:20800
  v_sub_f32 v12, v12, v2
  v_mul_f32 v12, v12, v5
  v_exp_f32 v12, v12
  v_mfma_f32_16x16x32_bf16 v[24:27], v[76:79], v[100:103], v[24:27]
  v_mfma_f32_16x16x32_bf16 v[28:31], v[76:79], v[104:107], v[28:31]
  s_waitcnt vmcnt(27) lgkmcnt(1)
  buffer_load_dwordx4 v[100:103], v62, s[24:27], s48 offen nt
  buffer_load_dwordx4 v[104:107], v62, s[24:27], s48 offen offset:256 nt
  ds_read_b128 v[72:75], v1 offset:21840
  v_mfma_f32_16x16x32_bf16 v[24:27], v[80:83], v[108:111], v[24:27]
  v_mfma_f32_16x16x32_bf16 v[28:31], v[80:83], v[112:115], v[28:31]
  v_cvt_pk_bf16_f32 v13, v12, 0
  v_cvt_pk_bf16_f32 v14, 0, v12
  v_add_f32 v3, v3, v14
  ds_write2_b32 v39, v13, v14 offset0:0 offset1:4
  ds_write2_b32 v39, v13, v14 offset0:9 offset1:13
  ds_write2_b32 v39, v13, v14 offset0:18 offset1:22
  ds_write2_b32 v39, v13, v14 offset0:27 offset1:31
  s_waitcnt vmcnt(27) lgkmcnt(5)
  buffer_load_dwordx4 v[108:111], v63, s[24:27], s48 offen nt
  buffer_load_dwordx4 v[112:115], v63, s[24:27], s48 offen offset:256 nt
  buffer_store_dword v42, v41, s[36:39], s52 offen
  buffer_load_dword v36, v40, s[36:39], s52 offen sc1
  ds_read_b128 v[76:79], v1 offset:22880
  v_mfma_f32_16x16x32_bf16 v[24:27], v[68:71], v[116:119], v[24:27]
  v_mfma_f32_16x16x32_bf16 v[28:31], v[68:71], v[120:123], v[28:31]
  s_waitcnt vmcnt(27) lgkmcnt(5)
  buffer_load_dwordx4 v[116:119], v64, s[24:27], s48 offen nt
  buffer_load_dwordx4 v[120:123], v64, s[24:27], s48 offen offset:256 nt
  ds_read_b128 v[80:83], v1 offset:23920
  v_mfma_f32_16x16x32_bf16 v[24:27], v[72:75], v[124:127], v[24:27]
  v_mfma_f32_16x16x32_bf16 v[28:31], v[72:75], v[128:131], v[28:31]
  s_waitcnt vmcnt(27) lgkmcnt(1)
  buffer_load_dwordx4 v[124:127], v65, s[24:27], s48 offen nt
  buffer_load_dwordx4 v[128:131], v65, s[24:27], s48 offen offset:256 nt
  ds_read_b128 v[68:71], v1 offset:24960
  v_mfma_f32_16x16x32_bf16 v[24:27], v[76:79], v[132:135], v[24:27]
  v_mfma_f32_16x16x32_bf16 v[28:31], v[76:79], v[136:139], v[28:31]
  s_waitcnt vmcnt(27) lgkmcnt(1)
  buffer_load_dwordx4 v[132:135], v66, s[24:27], s48 offen nt
  buffer_load_dwordx4 v[136:139], v66, s[24:27], s48 offen offset:256 nt
  ds_read_b128 v[72:75], v1 offset:26000
  v_mfma_f32_16x16x32_bf16 v[24:27], v[80:83], v[140:143], v[24:27]
  v_mfma_f32_16x16x32_bf16 v[28:31], v[80:83], v[144:147], v[28:31]
  s_branch L_v0_done
L_v0_0:
  s_waitcnt vmcnt(19) lgkmcnt(1)
  buffer_load_dwordx4 v[204:207], v67, s[28:31], s49 offen nt
  buffer_load_dwordx4 v[208:211], v67, s[28:31], s49 offen offset:256 nt
  buffer_store_dword v42, v41, s[36:39], s52 offen
  buffer_load_dword v36, v40, s[36:39], s52 offen sc1
  ds_read_b128 v[76:79], v1 offset:18720
  ds_read_b32 v12, v34 offset:33280
  v_add_u32 v34, 0x100, v34
  v_mfma_f32_16x16x32_bf16 v[24:27], v[68:71], v[84:87], v[24:27]
  v_mfma_f32_16x16x32_bf16 v[28:31], v[68:71], v[88:91], v[28:31]
  s_waitcnt vmcnt(19) lgkmcnt(2)
  buffer_load_dwordx4 v[84:87], v60, s[24:27], s48 offen nt
  buffer_load_dwordx4 v[88:91], v60, s[24:27], s48 offen offset:256 nt
  ds_read_b128 v[80:83], v1 offset:19760
  v_mfma_f32_16x16x32_bf16 v[24:27], v[72:75], v[92:95], v[24:27]
  v_mfma_f32_16x16x32_bf16 v[28:31], v[72:75], v[96:99], v[28:31]
  s_waitcnt vmcnt(19) lgkmcnt(1)
  buffer_load_dwordx4 v[92:95], v61, s[24:27], s48 offen nt
  buffer_load_dwordx4 v[96:99], v61, s[24:27], s48 offen offset:256 nt
  ds_read_b128 v[68:71], v1 offset:20800
  v_sub_f32 v12, v12, v2
  v_mul_f32 v12, v12, v5
  v_exp_f32 v12, v12
  v_mfma_f32_16x16x32_bf16 v[24:27], v[76:79], v[100:103], v[24:27]
  v_mfma_f32_16x16x32_bf16 v[28:31], v[76:79], v[104:107], v[28:31]
  s_waitcnt vmcnt(19) lgkmcnt(1)
  buffer_load_dwordx4 v[100:103], v62, s[24:27], s48 offen nt
  buffer_load_dwordx4 v[104:107], v62, s[24:27], s48 offen offset:256 nt
  ds_read_b128 v[72:75], v1 offset:21840
  v_mfma_f32_16x16x32_bf16 v[24:27], v[80:83], v[108:111], v[24:27]
  v_mfma_f32_16x16x32_bf16 v[28:31], v[80:83], v[112:115], v[28:31]
  v_cvt_pk_bf16_f32 v13, v12, 0
  v_cvt_pk_bf16_f32 v14, 0, v12
  v_add_f32 v3, v3, v14
  ds_write2_b32 v39, v13, v14 offset0:0 offset1:4
  ds_write2_b32 v39, v13, v14 offset0:9 offset1:13
  ds_write2_b32 v39, v13, v14 offset0:18 offset1:22
  ds_write2_b32 v39, v13, v14 offset0:27 offset1:31
  s_waitcnt vmcnt(19) lgkmcnt(5)
  buffer_load_dwordx4 v[108:111], v63, s[24:27], s48 offen nt
  buffer_load_dwordx4 v[112:115], v63, s[24:27], s48 offen offset:256 nt
  ds_read_b128 v[76:79], v1 offset:22880
  v_mfma_f32_16x16x32_bf16 v[24:27], v[68:71], v[116:119], v[24:27]
  v_mfma_f32_16x16x32_bf16 v[28:31], v[68:71], v[120:123], v[28:31]
  s_waitcnt vmcnt(19) lgkmcnt(5)
  buffer_load_dwordx4 v[116:119], v64, s[24:27], s48 offen nt
  buffer_load_dwordx4 v[120:123], v64, s[24:27], s48 offen offset:256 nt
  ds_read_b128 v[80:83], v1 offset:23920
  v_mfma_f32_16x16x32_bf16 v[24:27], v[72:75], v[124:127], v[24:27]
  v_mfma_f32_16x16x32_bf16 v[28:31], v[72:75], v[128:131], v[28:31]
  s_waitcnt vmcnt(19) lgkmcnt(1)
  buffer_load_dwordx4 v[124:127], v65, s[24:27], s48 offen nt
  buffer_load_dwordx4 v[128:131], v65, s[24:27], s48 offen offset:256 nt
  ds_read_b128 v[68:71], v1 offset:24960
  v_mfma_f32_16x16x32_bf16 v[24:27], v[76:79], v[132:135], v[24:27]
  v_mfma_f32_16x16x32_bf16 v[28:31], v[76:79], v[136:139], v[28:31]
  s_waitcnt vmcnt(19) lgkmcnt(1)
  buffer_load_dwordx4 v[132:135], v66, s[24:27], s48 offen nt
  buffer_load_dwordx4 v[136:139], v66, s[24:27], s48 offen offset:256 nt
  ds_read_b128 v[72:75], v1 offset:26000
  v_mfma_f32_16x16x32_bf16 v[24:27], v[80:83], v[140:143], v[24:27]
  v_mfma_f32_16x16x32_bf16 v[28:31], v[80:83], v[144:147], v[28:31]
  s_branch L_v0_done
L_v1_2:
  s_cmp_gt_i32 s40, 50
  s_cbranch_scc1 L_v1_3
  s_waitcnt vmcnt(23) lgkmcnt(1)
  buffer_load_dwordx4 v[140:143], v67, s[24:27], s48 offen nt
  buffer_load_dwordx4 v[144:147], v67, s[24:27], s48 offen offset:256 nt
  ds_read_b128 v[76:79], v1 offset:27040
  ds_read_b32 v12, v34 offset:33280
  v_add_u32 v34, 0x100, v34
  v_mfma_f32_16x16x32_bf16 v[24:27], v[68:71], v[148:151], v[24:27]
  v_mfma_f32_16x16x32_bf16 v[28:31], v[68:71], v[152:155], v[28:31]
  s_waitcnt vmcnt(23) lgkmcnt(2)
  buffer_load_dwordx4 v[148:151], v60, s[28:31], s49 offen nt
  buffer_load_dwordx4 v[152:155], v60, s[28:31], s49 offen offset:256 nt
  ds_read_b128 v[80:83], v1 offset:28080
  v_mfma_f32_16x16x32_bf16 v[24:27], v[72:75], v[156:159], v[24:27]
  v_mfma_f32_16x16x32_bf16 v[28:31], v[72:75], v[160:163], v[28:31]
  s_waitcnt vmcnt(23) lgkmcnt(1)
  buffer_load_dwordx4 v[156:159], v61, s[28:31], s49 offen nt
  buffer_load_dwordx4 v[160:163], v61, s[28:31], s49 offen offset:256 nt
  buffer_store_dword v42, v41, s[36:39], s52 offen
  buffer_load_dword v37, v40, s[36:39], s52 offen sc1
  ds_read_b128 v[68:71], v1 offset:29120
  v_sub_f32 v12, v12, v2
  v_mul_f32 v12, v12, v5
  v_exp_f32 v12, v12
  v_mfma_f32_16x16x32_bf16 v[24:27], v[76:79], v[164:167], v[24:27]
  v_mfma_f32_16x16x32_bf16 v[28:31], v[76:79], v[168:171], v[28:31]
  s_waitcnt vmcnt(23) lgkmcnt(1)
  buffer_load_dwordx4 v[164:167], v62, s[28:31], s49 offen nt
  buffer_load_dwordx4 v[168:171], v62, s[28:31], s49 offen offset:256 nt
  ds_read_b128 v[72:75], v1 offset:30160
  v_mfma_f32_16x16x32_bf16 v[24:27], v[80:83], v[172:175], v[24:27]
  v_mfma_f32_16x16x32_bf16 v[28:31], v[80:83], v[176:179], v[28:31]
  v_cvt_pk_bf16_f32 v13, v12, 0
  v_cvt_pk_bf16_f32 v14, 0, v12
  v_add_f32 v3, v3, v14
  ds_write2_b32 v38, v13, v14 offset0:0 offset1:4
  ds_write2_b32 v38, v13, v14 offset0:9 offset1:13
  ds_write2_b32 v38, v13, v14 offset0:18 offset1:22
  ds_write2_b32 v38, v13, v14 offset0:27 offset1:31
  s_waitcnt vmcnt(23) lgkmcnt(5)
  buffer_load_dwordx4 v[172:175], v63, s[28:31], s49 offen nt
  buffer_load_dwordx4 v[176:179], v63, s[28:31], s49 offen offset:256 nt
  ds_read_b128 v[76:79], v1 offset:31200
  v_mfma_f32_16x16x32_bf16 v[24:27], v[68:71], v[180:183], v[24:27]
  v_mfma_f32_16x16x32_bf16 v[28:31], v[68:71], v[184:187], v[28:31]
  s_waitcnt vmcnt(23) lgkmcnt(5)
  buffer_load_dwordx4 v[180:183], v64, s[28:31], s49 offen nt
  buffer_load_dwordx4 v[184:187], v64, s[28:31], s49 offen offset:256 nt
  ds_read_b128 v[80:83], v1 offset:32240
  v_mfma_f32_16x16x32_bf16 v[24:27], v[72:75], v[188:191], v[24:27]
  v_mfma_f32_16x16x32_bf16 v[28:31], v[72:75], v[192:195], v[28:31]
  s_waitcnt vmcnt(23) lgkmcnt(1)
  buffer_load_dwordx4 v[188:191], v65, s[28:31], s49 offen nt
  buffer_load_dwordx4 v[192:195], v65, s[28:31], s49 offen offset:256 nt
  ds_read_b128 v[68:71], v1 offset:16640
  v_mfma_f32_16x16x32_bf16 v[24:27], v[76:79], v[196:199], v[24:27]
  v_mfma_f32_16x16x32_bf16 v[28:31], v[76:79], v[200:203], v[28:31]
  s_waitcnt vmcnt(23) lgkmcnt(1)
  buffer_load_dwordx4 v[196:199], v66, s[28:31], s49 offen nt
  buffer_load_dwordx4 v[200:203], v66, s[28:31], s49 offen offset:256 nt
  ds_read_b128 v[72:75], v1 offset:17680
  v_mfma_f32_16x16x32_bf16 v[24:27], v[80:83], v[204:207], v[24:27]
  v_mfma_f32_16x16x32_bf16 v[28:31], v[80:83], v[208:211], v[28:31]
  s_branch L_v1_done
L_v1_3:
  s_waitcnt vmcnt(27) lgkmcnt(1)
  buffer_load_dwordx4 v[140:143], v67, s[24:27], s48 offen nt
  buffer_load_dwordx4 v[144:147], v67, s[24:27], s48 offen offset:256 nt
  ds_read_b128 v[76:79], v1 offset:27040
  ds_read_b32 v12, v34 offset:33280
  v_add_u32 v34, 0x100, v34
  v_mfma_f32_16x16x32_bf16 v[24:27], v[68:71], v[148:151], v[24:27]
  v_mfma_f32_16x16x32_bf16 v[28:31], v[68:71], v[152:155], v[28:31]
  s_waitcnt vmcnt(27) lgkmcnt(2)
  buffer_load_dwordx4 v[148:151], v60, s[28:31], s49 offen nt
  buffer_load_dwordx4 v[152:155], v60, s[28:31], s49 offen offset:256 nt
  ds_read_b128 v[80:83], v1 offset:28080
  v_mfma_f32_16x16x32_bf16 v[24:27], v[72:75], v[156:159], v[24:27]
  v_mfma_f32_16x16x32_bf16 v[28:31], v[72:75], v[160:163], v[28:31]
  s_waitcnt vmcnt(27) lgkmcnt(1)
  buffer_load_dwordx4 v[156:159], v61, s[28:31], s49 offen nt
  buffer_load_dwordx4 v[160:163], v61, s[28:31], s49 offen offset:256 nt
  ds_read_b128 v[68:71], v1 offset:29120
  v_sub_f32 v12, v12, v2
  v_mul_f32 v12, v12, v5
  v_exp_f32 v12, v12
  v_mfma_f32_16x16x32_bf16 v[24:27], v[76:79], v[164:167], v[24:27]
  v_mfma_f32_16x16x32_bf16 v[28:31], v[76:79], v[168:171], v[28:31]
  s_waitcnt vmcnt(27) lgkmcnt(1)
  buffer_load_dwordx4 v[164:167], v62, s[28:31], s49 offen nt
  buffer_load_dwordx4 v[168:171], v62, s[28:31], s49 offen offset:256 nt
  ds_read_b128 v[72:75], v1 offset:30160
  v_mfma_f32_16x16x32_bf16 v[24:27], v[80:83], v[172:175], v[24:27]
  v_mfma_f32_16x16x32_bf16 v[28:31], v[80:83], v[176:179], v[28:31]
  v_cvt_pk_bf16_f32 v13, v12, 0
  v_cvt_pk_bf16_f32 v14, 0, v12
  v_add_f32 v3, v3, v14
  ds_write2_b32 v38, v13, v14 offset0:0 offset1:4
  ds_write2_b32 v38, v13, v14 offset0:9 offset1:13
  ds_write2_b32 v38, v13, v14 offset0:18 offset1:22
  ds_write2_b32 v38, v13, v14 offset0:27 offset1:31
  s_waitcnt vmcnt(27) lgkmcnt(5)
  buffer_load_dwordx4 v[172:175], v63, s[28:31], s49 offen nt
  buffer_load_dwordx4 v[176:179], v63, s[28:31], s49 offen offset:256 nt
  buffer_store_dword v42, v41, s[36:39], s52 offen
  buffer_load_dword v37, v40, s[36:39], s52 offen sc1
  ds_read_b128 v[76:79], v1 offset:31200
  v_mfma_f32_16x16x32_bf16 v[24:27], v[68:71], v[180:183], v[24:27]
  v_mfma_f32_16x16x32_bf16 v[28:31], v[68:71], v[184:187], v[28:31]
  s_waitcnt vmcnt(27) lgkmcnt(5)
  buffer_load_dwordx4 v[180:183], v64, s[28:31], s49 offen nt
  buffer_load_dwordx4 v[184:187], v64, s[28:31], s49 offen offset:256 nt
  ds_read_b128 v[80:83], v1 offset:32240
  v_mfma_f32_16x16x32_bf16 v[24:27], v[72:75], v[188:191], v[24:27]
  v_mfma_f32_16x16x32_bf16 v[28:31], v[72:75], v[192:195], v[28:31]
  s_waitcnt vmcnt(27) lgkmcnt(1)
  buffer_load_dwordx4 v[188:191], v65, s[28:31], s49 offen nt
  buffer_load_dwordx4 v[192:195], v65, s[28:31], s49 offen offset:256 nt
  ds_read_b128 v[68:71], v1 offset:16640
  v_mfma_f32_16x16x32_bf16 v[24:27], v[76:79], v[196:199], v[24:27]
  v_mfma_f32_16x16x32_bf16 v[28:31], v[76:79], v[200:203], v[28:31]
  s_waitcnt vmcnt(27) lgkmcnt(1)
  buffer_load_dwordx4 v[196:199], v66, s[28:31], s49 offen nt
  buffer_load_dwordx4 v[200:203], v66, s[28:31], s49 offen offset:256 nt
  ds_read_b128 v[72:75], v1 offset:17680
  v_mfma_f32_16x16x32_bf16 v[24:27], v[80:83], v[204:207], v[24:27]
  v_mfma_f32_16x16x32_bf16 v[28:31], v[80:83], v[208:211], v[28:31]
  s_branch L_v1_done
L_v1_0:
  s_waitcnt vmcnt(19) lgkmcnt(1)
  buffer_load_dwordx4 v[140:143], v67, s[24:27], s48 offen nt
  buffer_load_dwordx4 v[144:147], v67, s[24:27], s48 offen offset:256 nt
  buffer_store_dword v42, v41, s[36:39], s52 offen
  buffer_load_dword v37, v40, s[36:39], s52 offen sc1
  ds_read_b128 v[76:79], v1 offset:27040
  ds_read_b32 v12, v34 offset:33280
  v_add_u32 v34, 0x100, v34
  v_mfma_f32_16x16x32_bf16 v[24:27], v[68:71], v[148:151], v[24:27]
  v_mfma_f32_16x16x32_bf16 v[28:31], v[68:71], v[152:155], v[28:31]
  s_waitcnt vmcnt(19) lgkmcnt(2)
  buffer_load_dwordx4 v[148:151], v60, s[28:31], s49 offen nt
  buffer_load_dwordx4 v[152:155], v60, s[28:31], s49 offen offset:256 nt
  ds_read_b128 v[80:83], v1 offset:28080
  v_mfma_f32_16x16x32_bf16 v[24:27], v[72:75], v[156:159], v[24:27]
  v_mfma_f32_16x16x32_bf16 v[28:31], v[72:75], v[160:163], v[28:31]
  s_waitcnt vmcnt(19) lgkmcnt(1)
  buffer_load_dwordx4 v[156:159], v61, s[28:31], s49 offen nt
  buffer_load_dwordx4 v[160:163], v61, s[28:31], s49 offen offset:256 nt
  ds_read_b128 v[68:71], v1 offset:29120
  v_sub_f32 v12, v12, v2
  v_mul_f32 v12, v12, v5
  v_exp_f32 v12, v12
  v_mfma_f32_16x16x32_bf16 v[24:27], v[76:79], v[164:167], v[24:27]
  v_mfma_f32_16x16x32_bf16 v[28:31], v[76:79], v[168:171], v[28:31]
  s_waitcnt vmcnt(19) lgkmcnt(1)
  buffer_load_dwordx4 v[164:167], v62, s[28:31], s49 offen nt
  buffer_load_dwordx4 v[168:171], v62, s[28:31], s49 offen offset:256 nt
  ds_read_b128 v[72:75], v1 offset:30160
  v_mfma_f32_16x16x32_bf16 v[24:27], v[80:83], v[172:175], v[24:27]
  v_mfma_f32_16x16x32_bf16 v[28:31], v[80:83], v[176:179], v[28:31]
  v_cvt_pk_bf16_f32 v13, v12, 0
  v_cvt_pk_bf16_f32 v14, 0, v12
  v_add_f32 v3, v3, v14
  ds_write2_b32 v38, v13, v14 offset0:0 offset1:4
  ds_write2_b32 v38, v13, v14 offset0:9 offset1:13
  ds_write2_b32 v38, v13, v14 offset0:18 offset1:22
  ds_write2_b32 v38, v13, v14 offset0:27 offset1:31
  s_waitcnt vmcnt(19) lgkmcnt(5)
  buffer_load_dwordx4 v[172:175], v63, s[28:31], s49 offen nt
  buffer_load_dwordx4 v[176:179], v63, s[28:31], s49 offen offset:256 nt
  ds_read_b128 v[76:79], v1 offset:31200
  v_mfma_f32_16x16x32_bf16 v[24:27], v[68:71], v[180:183], v[24:27]
  v_mfma_f32_16x16x32_bf16 v[28:31], v[68:71], v[184:187], v[28:31]
  s_waitcnt vmcnt(19) lgkmcnt(5)
  buffer_load_dwordx4 v[180:183], v64, s[28:31], s49 offen nt
  buffer_load_dwordx4 v[184:187], v64, s[28:31], s49 offen offset:256 nt
  ds_read_b128 v[80:83], v1 offset:32240
  v_mfma_f32_16x16x32_bf16 v[24:27], v[72:75], v[188:191], v[24:27]
  v_mfma_f32_16x16x32_bf16 v[28:31], v[72:75], v[192:195], v[28:31]
  s_waitcnt vmcnt(19) lgkmcnt(1)
  buffer_load_dwordx4 v[188:191], v65, s[28:31], s49 offen nt
  buffer_load_dwordx4 v[192:195], v65, s[28:31], s49 offen offset:256 nt
  ds_read_b128 v[68:71], v1 offset:16640
  v_mfma_f32_16x16x32_bf16 v[24:27], v[76:79], v[196:199], v[24:27]
  v_mfma_f32_16x16x32_bf16 v[28:31], v[76:79], v[200:203], v[28:31]
  s_waitcnt vmcnt(19) lgkmcnt(1)
  buffer_load_dwordx4 v[196:199], v66, s[28:31], s49 offen nt
  buffer_load_dwordx4 v[200:203], v66, s[28:31], s49 offen offset:256 nt
  ds_read_b128 v[72:75], v1 offset:17680
  v_mfma_f32_16x16x32_bf16 v[24:27], v[80:83], v[204:207], v[24:27]
  v_mfma_f32_16x16x32_bf16 v[28:31], v[80:83], v[208:211], v[28:31]
  s_branch L_v1_done
L_codeend:
.section .rodata,"a"
.p2align 6
.amdhsa_kernel standalone__tree_speculative_verify_tree_attention_over_candidate_token_tree__decode_kernel
  .amdhsa_next_free_vgpr 248
  .amdhsa_next_free_sgpr 64
  .amdhsa_accum_offset 248
  .amdhsa_group_segment_fixed_size 0
  .amdhsa_kernarg_size 72
  .amdhsa_user_sgpr_count 2
  .amdhsa_user_sgpr_kernarg_segment_ptr 1
  .amdhsa_system_sgpr_workgroup_id_x 1
.end_amdhsa_kernel
```
